```python
import torch

def _softmax(x, axis=-1):
    return torch.softmax(x, dim=axis)

def _gelu(x):
    return torch.nn.functional.gelu(x, approximate='tanh')

def _silu(x):
    return torch.nn.functional.silu(x)

def _sigmoid(x):
    return torch.sigmoid(x)

def _layernorm(x, axis=-1, eps=1e-05):
    m = x.mean(dim=axis, keepdim=True)
    v = x.var(dim=axis, keepdim=True, unbiased=False)
    return (x - m) / torch.sqrt(v + eps)

def _scatter_add(tgt, idx, src, axis=0):
    return tgt.clone().index_add_(axis, idx, src)

def _segment_sum(src, seg, n):
    out = torch.zeros((n,) + src.shape[1:], dtype=src.dtype)
    return out.index_add_(0, seg, src)

def _pad(x, pw):
    flat = tuple((v for pair in reversed(pw) for v in pair))
    return torch.nn.functional.pad(x, flat)
kernel_name = 'adaLN_cond__gqa_block_cached__dense_activation_relu__decode'

def setup_inputs():

    _w = lambda a: (lambda t: t.to(torch.bfloat16) if t.is_floating_point() else t)(torch.as_tensor(a))

    def _A_setup():
        B, Sq, D = (1, 1, 512)
        Hq, Hkv, Sk, Dh = (32, 8, 32768, 128)
        assert Hq % Hkv == 0, (Hq, Hkv)
        return {'x': _w((lambda *s: torch.randn(*s, dtype=torch.bfloat16) * 0.1)(B, Sq, D)), 'k_cache': _w((lambda *s: torch.randn(*s, dtype=torch.bfloat16) * 0.8)(B, Hkv, Sk, Dh)), 'v_cache': _w((lambda *s: torch.randn(*s, dtype=torch.bfloat16) * 1.6)(B, Hkv, Sk, Dh)), 'wq': _w((lambda *s: torch.randn(*s, dtype=torch.bfloat16) * 0.8)(D, Hq * Dh) * D ** (-0.5)), 'wo': _w((lambda *s: torch.randn(*s, dtype=torch.bfloat16) * 1.6)(Hq * Dh, D) * (Hq * Dh) ** (-0.5))}
    _A_in = _A_setup()

    def _B_setup():
        B, S, D, Dff = (1, 1, 512, 1792)
        return {'x': _w((lambda *s: torch.randn(*s, dtype=torch.bfloat16) * 0.1)(B, S, D)), 'w1': _w((lambda *s: torch.randn(*s, dtype=torch.bfloat16) * 0.1)(D, Dff)), 'w2': _w((lambda *s: torch.randn(*s, dtype=torch.bfloat16) * 0.1)(Dff, D))}
    _B_in = _B_setup()
    return {'A_x': _A_in['x'], 'A_k_cache': _A_in['k_cache'], 'A_v_cache': _A_in['v_cache'], 'A_wq': _A_in['wq'], 'A_wo': _A_in['wo'], 'B_x': _B_in['x'], 'B_w1': _B_in['w1'], 'B_w2': _B_in['w2'], 'c': _w((lambda *s: torch.randn(*s, dtype=torch.bfloat16) * 0.2)(1, 512) * 8.0), 'w_mod': _w((lambda *s: torch.randn(*s, dtype=torch.bfloat16) * 0.2)(512, 6 * 512) * 512 ** (-0.5) * 8.0)}

def reference(A_x, A_k_cache, A_v_cache, A_wq, A_wo, B_x, B_w1, B_w2, c, w_mod):

    def _A_ref(x, k_cache, v_cache, wq, wo):
        B, Sq, D = x.shape
        Hq, Dh = (32, 128)
        Hkv = k_cache.shape[1]
        rep = Hq // Hkv
        q = (lambda x, *d: x.permute(*d))((x @ wq).reshape(B, Sq, Hq, Dh), 0, 2, 1, 3)
        k = (lambda x, n, axis: torch.repeat_interleave(x, n, dim=axis))(k_cache, rep, axis=1)
        v = (lambda x, n, axis: torch.repeat_interleave(x, n, dim=axis))(v_cache, rep, axis=1)
        scores = torch.einsum('bhqd,bhkd->bhqk', q, k) * Dh ** (-0.5)
        p = _softmax(scores, axis=-1)
        o = torch.einsum('bhqk,bhkd->bhqd', p, v)
        return (lambda x, *d: x.permute(*d))(o, 0, 2, 1, 3).reshape(B, Sq, Hq * Dh) @ wo

    def _B_ref(x, w1, w2):
        h = torch.einsum('bsd,df->bsf', x, w1)
        zero = torch.zeros_like(h)
        h = torch.maximum(h, zero)
        return torch.einsum('bsf,fd->bsd', h, w2)
    x = A_x
    mod = (_silu(c) @ w_mod).reshape(c.shape[0], 6, 1, -1)
    sa, ca, ga, sb, cb, gb = (mod[:, 0].clone(), mod[:, 1].clone(), mod[:, 2].clone(), mod[:, 3].clone(), mod[:, 4].clone(), mod[:, 5].clone())
    h = _layernorm(x, axis=-1) * (1 + ca) + sa
    x = x + ga * _A_ref(h, A_k_cache, A_v_cache, A_wq, A_wo)
    h = _layernorm(x, axis=-1) * (1 + cb) + sb
    x = x + gb * _B_ref(h, B_w1, B_w2)
    return x
```

```asm
; @launch grid=(256,1,1) block=(768,1,1) lds=98304
.amdgcn_target "amdgcn-amd-amdhsa--gfx950"
.text
.globl adaLN_cond__gqa_block_cached__dense_activation_relu__decode_kernel
.p2align 8
.type adaLN_cond__gqa_block_cached__dense_activation_relu__decode_kernel,@function
adaLN_cond__gqa_block_cached__dense_activation_relu__decode_kernel:
    s_cmp_ge_u32 s2, 256
    s_cbranch_scc1 L_exit
    s_load_dwordx16 s[36:51], s[0:1], 0
    s_getpc_b64 s[30:31]
L_pc:
    s_add_u32 s32, s30, L_tab-L_pc
    s_addc_u32 s33, s31, 0
    s_lshl_b32 s34, s2, 2
    v_lshrrev_b32 v1, 6, v0
    v_and_b32 v0, 63, v0
    v_readfirstlane_b32 s3, v1
    s_and_b32 s4, s2, 7
    s_lshr_b32 s5, s2, 3
    s_mov_b32 s24, 0x05040100
    s_mov_b32 s25, 0x07060302
    v_lshlrev_b32 v2, 4, v0
    s_cmp_lt_u32 s3, 4
    s_cbranch_scc1 L_service
L_stream:
    s_sub_u32 s21, s3, 4
    v_bfe_u32 v1, v0, 2, 2
    v_lshlrev_b32 v1, 8, v1
    v_lshrrev_b32 v4, 4, v0
    v_lshl_add_u32 v1, v4, 6, v1
    v_and_b32 v4, 3, v0
    v_lshl_add_u32 v1, v4, 4, v1
    s_lshl_b32 s19, s4, 23
    s_mul_i32 s16, s5, 229376
    s_add_u32 s16, s16, s19
    s_lshl_b32 s17, s21, 12
    s_add_u32 s16, s16, s17
    s_mov_b32 s10, 0x4000000
    s_mov_b32 s11, 0x20000
    s_lshl_b32 s17, s4, 2
    s_lshr_b32 s35, 0x8080808, s17
    s_and_b32 s35, s35, 15
    s_waitcnt lgkmcnt(0)
    s_mov_b32 s8, s38
    s_mov_b32 s9, s39
    s_cmp_ge_u32 s5, s35
    s_cbranch_scc1 L_s1
    s_barrier
L_s1:
    s_add_u32 s20, s16, 0
    buffer_load_dwordx4 v[32:35], v1, s[8:11], s20 offen offset:0 nt
    buffer_load_dwordx4 v[36:39], v1, s[8:11], s20 offen offset:1024 nt
    buffer_load_dwordx4 v[40:43], v1, s[8:11], s20 offen offset:2048 nt
    s_load_dwordx8 s[52:59], s[0:1], 64
    s_load_dwordx2 s[60:61], s[0:1], 96
    s_load_dword s68, s[32:33], s34
    s_branch L_body
L_service:
    s_load_dwordx8 s[52:59], s[0:1], 64
    s_load_dwordx2 s[60:61], s[0:1], 96
    s_load_dword s68, s[32:33], s34
    s_setprio 3
    s_lshl_b32 s20, s5, 2
    s_add_u32 s20, s20, s3
    s_sub_u32 s20, s20, 96
    s_cmp_ge_u32 s20, (L_endcode-adaLN_cond__gqa_block_cached__dense_activation_relu__decode_kernel)/1024
    s_cbranch_scc1 L_ncp
    s_sub_u32 s30, s30, L_pc-adaLN_cond__gqa_block_cached__dense_activation_relu__decode_kernel
    s_subb_u32 s31, s31, 0
    s_lshl_b32 s20, s20, 10
    v_add_u32 v14, s20, v2
    global_load_dwordx4 v[164:167], v14, s[30:31]
L_ncp:
    v_lshrrev_b32 v12, 3, v0
    v_and_b32 v13, 7, v0
    v_mov_b32 v16, 0
    v_mov_b32 v17, 0
    v_mov_b32 v18, 0
    v_mov_b32 v19, 0
    s_mov_b64 exec, 0x1f
    ds_write_b128 v2, v[16:19]
    s_mov_b64 exec, -1
    s_waitcnt lgkmcnt(0)
    s_bfe_u32 s64, s68, 0x3000f
    s_bfe_u32 s65, s68, 0x50012
    s_bfe_u32 s66, s68, 0x20017
    s_bfe_u32 s67, s68, 0x60019
    s_lshr_b32 s69, s65, 2
    s_and_b32 s70, s65, 3
    s_cmp_eq_u32 s64, 1
    s_cbranch_scc1 L_h
    s_cmp_eq_u32 s64, 2
    s_cbranch_scc1 L_nh
    s_load_dword s6, s[60:61], 0
    s_waitcnt lgkmcnt(0)
    s_mul_i32 s6, s6, 0x9E3779B1
    s_add_u32 s6, s6, 0x7F4A7C15
    s_barrier
    s_branch L_role
L_h:
    s_lshr_b32 s20, s70, 1
    s_lshl_b32 s20, s20, 8
    s_lshl_b32 s21, s3, 6
    s_add_u32 s20, s20, s21
    v_lshl_add_u32 v14, v12, 3, s20
    s_mov_b32 s21, 6144
    v_mul_lo_u32 v1, v14, s21
    v_lshl_add_u32 v1, v13, 4, v1
    v_lshlrev_b32 v14, 1, v14
    s_and_b32 s20, s70, 1
    s_lshl_b32 s20, s20, 10
    s_lshl_b32 s21, s69, 7
    s_add_u32 s20, s20, s21
    s_waitcnt lgkmcnt(0)
    s_mov_b32 s8, s54
    s_mov_b32 s9, s55
    s_mov_b32 s10, 3145728
    s_mov_b32 s11, 0x20000
    global_load_dwordx4 v[4:7], v14, s[52:53]
    buffer_load_dwordx4 v[40:43], v1, s[8:11], s20 offen
    s_add_u32 s20, s20, 6144
    buffer_load_dwordx4 v[44:47], v1, s[8:11], s20 offen
    s_add_u32 s20, s20, 6144
    buffer_load_dwordx4 v[48:51], v1, s[8:11], s20 offen
    s_add_u32 s20, s20, 6144
    buffer_load_dwordx4 v[52:55], v1, s[8:11], s20 offen
    s_add_u32 s20, s20, 6144
    buffer_load_dwordx4 v[56:59], v1, s[8:11], s20 offen
    s_add_u32 s20, s20, 6144
    buffer_load_dwordx4 v[60:63], v1, s[8:11], s20 offen
    s_add_u32 s20, s20, 6144
    buffer_load_dwordx4 v[64:67], v1, s[8:11], s20 offen
    s_add_u32 s20, s20, 6144
    buffer_load_dwordx4 v[68:71], v1, s[8:11], s20 offen
    s_load_dword s6, s[60:61], 0
    s_barrier
    s_lshl_b32 s20, s65, 2
    s_add_u32 s20, s20, s3
    s_lshr_b32 s21, s20, 3
    s_lshl_b32 s21, s21, 15
    s_and_b32 s22, s20, 7
    s_lshl_b32 s22, s22, 11
    s_add_u32 s21, s21, s22
    s_add_u32 s21, s21, 540672
    v_lshrrev_b32 v14, 2, v0
    v_lshl_add_u32 v14, v14, 6, v2
    v_add_u32 v14, s21, v14
    v_add_u32 v11, 16384, v14
    s_lshr_b32 s21, s20, 5
    s_lshl_b32 s21, s21, 15
    s_and_b32 s22, s20, 31
    s_lshl_b32 s22, s22, 9
    s_add_u32 s21, s21, s22
    s_add_u32 s21, s21, 262144
    v_add_u32 v15, s21, v2
    s_cmp_eq_u32 s3, 3
    s_cselect_b32 exec_hi, 0, -1
    v_mov_b32 v16, -1
    v_mov_b32 v17, -1
    v_mov_b32 v18, -1
    v_mov_b32 v19, -1
    s_mov_b64 exec, -1
    v_mov_b32 v20, -1
    v_mov_b32 v21, -1
    v_mov_b32 v22, -1
    v_mov_b32 v23, -1
    global_store_dwordx4 v14, v[16:19], s[60:61] sc1
    s_mov_b32 exec_hi, 0
    global_store_dwordx4 v15, v[20:23], s[60:61] sc1
    s_mov_b64 exec, -1
    s_waitcnt vmcnt(10)
    v_lshlrev_b32 v24, 16, v4
    v_and_b32 v25, 0xffff0000, v4
    v_lshlrev_b32 v26, 16, v5
    v_and_b32 v27, 0xffff0000, v5
    v_lshlrev_b32 v28, 16, v6
    v_and_b32 v29, 0xffff0000, v6
    v_lshlrev_b32 v30, 16, v7
    v_and_b32 v31, 0xffff0000, v7
    s_mov_b32 s21, 0xbfb8aa3b
    v_mul_f32 v32, s21, v24
    v_mul_f32 v33, s21, v25
    v_mul_f32 v34, s21, v26
    v_mul_f32 v35, s21, v27
    v_mul_f32 v36, s21, v28
    v_mul_f32 v37, s21, v29
    v_mul_f32 v38, s21, v30
    v_mul_f32 v39, s21, v31
    v_exp_f32 v32, v32
    v_exp_f32 v33, v33
    v_exp_f32 v34, v34
    v_exp_f32 v35, v35
    v_exp_f32 v36, v36
    v_exp_f32 v37, v37
    v_exp_f32 v38, v38
    v_exp_f32 v39, v39
    v_add_f32 v32, 1.0, v32
    v_add_f32 v33, 1.0, v33
    v_add_f32 v34, 1.0, v34
    v_add_f32 v35, 1.0, v35
    v_add_f32 v36, 1.0, v36
    v_add_f32 v37, 1.0, v37
    v_add_f32 v38, 1.0, v38
    v_add_f32 v39, 1.0, v39
    v_rcp_f32 v32, v32
    v_rcp_f32 v33, v33
    v_rcp_f32 v34, v34
    v_rcp_f32 v35, v35
    v_rcp_f32 v36, v36
    v_rcp_f32 v37, v37
    v_rcp_f32 v38, v38
    v_rcp_f32 v39, v39
    v_mul_f32 v24, v24, v32
    v_mul_f32 v25, v25, v33
    v_mul_f32 v26, v26, v34
    v_mul_f32 v27, v27, v35
    v_mul_f32 v28, v28, v36
    v_mul_f32 v29, v29, v37
    v_mul_f32 v30, v30, v38
    v_mul_f32 v31, v31, v39
    v_cvt_pk_bf16_f32 v24, v24, v25
    v_cvt_pk_bf16_f32 v25, v26, v27
    v_cvt_pk_bf16_f32 v26, v28, v29
    v_cvt_pk_bf16_f32 v27, v30, v31
    s_waitcnt lgkmcnt(0)
    s_mul_i32 s6, s6, 0x9E3779B1
    s_add_u32 s6, s6, 0x7F4A7C15
    s_and_b32 s26, s70, 1
    s_lshl_b32 s26, s26, 13
    s_lshr_b32 s21, s70, 1
    s_lshl_b32 s21, s21, 12
    s_add_u32 s26, s26, s21
    s_lshl_b32 s21, s69, 9
    s_add_u32 s26, s26, s21
    s_add_u32 s26, s26, 98304
    s_waitcnt vmcnt(2)
    v_perm_b32 v104, v44, v40, s24
    v_perm_b32 v105, v44, v40, s25
    v_perm_b32 v106, v45, v41, s24
    v_perm_b32 v107, v45, v41, s25
    v_perm_b32 v108, v46, v42, s24
    v_perm_b32 v109, v46, v42, s25
    v_perm_b32 v110, v47, v43, s24
    v_perm_b32 v111, v47, v43, s25
    v_perm_b32 v112, v52, v48, s24
    v_perm_b32 v113, v52, v48, s25
    v_perm_b32 v114, v53, v49, s24
    v_perm_b32 v115, v53, v49, s25
    v_perm_b32 v116, v54, v50, s24
    v_perm_b32 v117, v54, v50, s25
    v_perm_b32 v118, v55, v51, s24
    v_perm_b32 v119, v55, v51, s25
    v_perm_b32 v120, v60, v56, s24
    v_perm_b32 v121, v60, v56, s25
    v_perm_b32 v122, v61, v57, s24
    v_perm_b32 v123, v61, v57, s25
    v_perm_b32 v124, v62, v58, s24
    v_perm_b32 v125, v62, v58, s25
    v_perm_b32 v126, v63, v59, s24
    v_perm_b32 v127, v63, v59, s25
    v_perm_b32 v128, v68, v64, s24
    v_perm_b32 v129, v68, v64, s25
    v_perm_b32 v130, v69, v65, s24
    v_perm_b32 v131, v69, v65, s25
    v_perm_b32 v132, v70, v66, s24
    v_perm_b32 v133, v70, v66, s25
    v_perm_b32 v134, v71, v67, s24
    v_perm_b32 v135, v71, v67, s25
    v_dot2_f32_bf16 v32, v104, v24, 0
    v_dot2_f32_bf16 v33, v105, v24, 0
    v_dot2_f32_bf16 v34, v106, v24, 0
    v_dot2_f32_bf16 v35, v107, v24, 0
    v_dot2_f32_bf16 v36, v108, v24, 0
    v_dot2_f32_bf16 v37, v109, v24, 0
    v_dot2_f32_bf16 v38, v110, v24, 0
    v_dot2_f32_bf16 v39, v111, v24, 0
    v_dot2_f32_bf16 v32, v112, v25, v32
    v_dot2_f32_bf16 v33, v113, v25, v33
    v_dot2_f32_bf16 v34, v114, v25, v34
    v_dot2_f32_bf16 v35, v115, v25, v35
    v_dot2_f32_bf16 v36, v116, v25, v36
    v_dot2_f32_bf16 v37, v117, v25, v37
    v_dot2_f32_bf16 v38, v118, v25, v38
    v_dot2_f32_bf16 v39, v119, v25, v39
    v_dot2_f32_bf16 v32, v120, v26, v32
    v_dot2_f32_bf16 v33, v121, v26, v33
    v_dot2_f32_bf16 v34, v122, v26, v34
    v_dot2_f32_bf16 v35, v123, v26, v35
    v_dot2_f32_bf16 v36, v124, v26, v36
    v_dot2_f32_bf16 v37, v125, v26, v37
    v_dot2_f32_bf16 v38, v126, v26, v38
    v_dot2_f32_bf16 v39, v127, v26, v39
    v_dot2_f32_bf16 v32, v128, v27, v32
    v_dot2_f32_bf16 v33, v129, v27, v33
    v_dot2_f32_bf16 v34, v130, v27, v34
    v_dot2_f32_bf16 v35, v131, v27, v35
    v_dot2_f32_bf16 v36, v132, v27, v36
    v_dot2_f32_bf16 v37, v133, v27, v37
    v_dot2_f32_bf16 v38, v134, v27, v38
    v_dot2_f32_bf16 v39, v135, v27, v39
L_gfin:
    v_permlane32_swap_b32 v32, v36
    v_permlane32_swap_b32 v33, v37
    v_permlane32_swap_b32 v34, v38
    v_permlane32_swap_b32 v35, v39
    v_add_f32 v32, v32, v36
    v_add_f32 v33, v33, v37
    v_add_f32 v34, v34, v38
    v_add_f32 v35, v35, v39
    s_nop 0
    v_permlane16_swap_b32 v32, v34
    v_permlane16_swap_b32 v33, v35
    v_add_f32 v32, v32, v34
    v_add_f32 v33, v33, v35
    s_nop 0
    v_add_f32_dpp v32, v32, v32 row_ror:8 row_mask:0xf bank_mask:0xf
    v_add_f32_dpp v33, v33, v33 row_ror:8 row_mask:0xf bank_mask:0xf
    v_lshrrev_b32 v14, 4, v0
    v_lshlrev_b32 v14, 3, v14
    v_lshl_add_u32 v14, v13, 5, v14
    s_lshl_b32 s21, s3, 8
    v_add_u32 v14, s21, v14
    ds_write_b64 v14, v[32:33] offset:2048
    v_mov_b32 v14, 0
    v_mov_b32 v15, 1
    s_waitcnt vmcnt(0)
    s_mov_b64 exec, 1
    ds_add_rtn_u32 v15, v14, v15 offset:0
    s_mov_b64 exec, -1
    v_lshlrev_b32 v14, 3, v0
    s_waitcnt lgkmcnt(0)
    v_readfirstlane_b32 s21, v15
    s_nop 0
    s_cmp_lg_u32 s21, 3
    s_cbranch_scc1 L_gdone
    s_mov_b32 exec_hi, 0
    ds_read_b64 v[32:33], v14 offset:2048
    ds_read_b64 v[34:35], v14 offset:2304
    ds_read_b64 v[36:37], v14 offset:2560
    ds_read_b64 v[38:39], v14 offset:2816
    v_add_u32 v14, s26, v14
    s_waitcnt lgkmcnt(0)
    v_pk_add_f32 v[32:33], v[32:33], v[34:35]
    v_pk_add_f32 v[36:37], v[36:37], v[38:39]
    v_pk_add_f32 v[32:33], v[32:33], v[36:37]
    s_cmp_lg_u32 s64, 1
    s_cbranch_scc1 L_gnh
    v_mov_b32 v34, v33
    v_mov_b32 v33, s6
    v_mov_b32 v35, s6
    v_add_u32 v14, s26, v2
    global_store_dwordx4 v14, v[32:35], s[60:61] sc1
    s_mov_b64 exec, -1
    s_branch L_gdone
L_gnh:
    v_cvt_pk_bf16_f32 v32, v32, v33
    v_mov_b32 v33, s6
    s_cmp_lg_u32 s64, 2
    s_cbranch_scc1 L_gnl
    v_add_u32 v15, 32768, v14
    global_store_dwordx2 v15, v[32:33], s[60:61]
L_gnl:
    global_store_dwordx2 v14, v[32:33], s[60:61] sc1
    s_mov_b64 exec, -1
L_gdone:
    s_branch L_qpoll
L_body:
    s_mov_b32 s12, s40
    s_mov_b32 s13, s41
    s_mov_b32 s14, 67108864
    s_mov_b32 s15, 0x20000
    s_waitcnt lgkmcnt(0)
    s_and_b32 s17, s68, 0xfff
    s_bfe_u32 s18, s68, 0x3000c
    s_add_u32 s17, s17, 880
    s_lshl_b32 s17, s17, 13
    s_add_u32 s17, s17, s19
    s_lshl_b32 s19, s21, 10
    s_add_u32 s17, s17, s19
    s_waitcnt vmcnt(2)
    buffer_load_dwordx4 v[44:47], v1, s[8:11], s20 offen offset:3072 nt
    s_waitcnt vmcnt(2)
    s_add_u32 s20, s16, 32768
    buffer_load_dwordx4 v[48:51], v1, s[8:11], s20 offen offset:0 nt
    s_waitcnt vmcnt(2)
    buffer_load_dwordx4 v[52:55], v1, s[8:11], s20 offen offset:1024 nt
    s_cmp_lt_u32 s5, s35
    s_cbranch_scc1 L_s2
    s_barrier
L_s2:
    s_add_u32 s20, s17, 0
    s_cmp_gt_u32 s18, 0
    s_cselect_b32 s20, 0x4000000, s20
    buffer_load_dwordx4 v[56:59], v1, s[8:11], s20 offen offset:0 nt
    s_waitcnt vmcnt(3)
    s_add_u32 s20, s17, 40960
    buffer_load_dwordx4 v[60:63], v1, s[8:11], s20 offen offset:0 nt
    s_waitcnt vmcnt(3)
    s_add_u32 s20, s16, 32768
    buffer_load_dwordx4 v[64:67], v1, s[8:11], s20 offen offset:2048 nt
    s_waitcnt vmcnt(3)
    buffer_load_dwordx4 v[68:71], v1, s[8:11], s20 offen offset:3072 nt
    s_add_u32 s20, s17, 8192
    s_cmp_gt_u32 s18, 1
    s_cselect_b32 s20, 0x4000000, s20
    buffer_load_dwordx4 v[72:75], v1, s[8:11], s20 offen offset:0 nt
    s_waitcnt vmcnt(3)
    s_add_u32 s20, s16, 65536
    buffer_load_dwordx4 v[76:79], v1, s[8:11], s20 offen offset:0 nt
    v_mov_b32 v8, 0
    v_mov_b32 v9, 1
    s_mov_b64 exec, 1
    ds_write_b32 v8, v9 offset:72
    s_mov_b64 exec, -1
    s_waitcnt vmcnt(3)
    buffer_load_dwordx4 v[80:83], v1, s[8:11], s20 offen offset:1024 nt
    s_waitcnt vmcnt(3)
    buffer_load_dwordx4 v[84:87], v1, s[8:11], s20 offen offset:2048 nt
    s_add_u32 s20, s17, 16384
    s_cmp_gt_u32 s18, 2
    s_cselect_b32 s20, 0x4000000, s20
    buffer_load_dwordx4 v[88:91], v1, s[8:11], s20 offen offset:0 nt
    s_waitcnt vmcnt(3)
    s_add_u32 s20, s16, 65536
    buffer_load_dwordx4 v[92:95], v1, s[8:11], s20 offen offset:3072 nt
    s_waitcnt vmcnt(3)
    s_add_u32 s20, s16, 98304
    buffer_load_dwordx4 v[96:99], v1, s[8:11], s20 offen offset:0 nt
    s_waitcnt vmcnt(3)
    buffer_load_dwordx4 v[100:103], v1, s[8:11], s20 offen offset:1024 nt
    v_mov_b32 v8, 0
    v_mov_b32 v9, 1
    s_mov_b64 exec, 1
    ds_max_u32 v8, v9 offset:20
    s_mov_b64 exec, -1
    s_waitcnt vmcnt(2)
    buffer_load_dwordx4 v[104:107], v1, s[8:11], s20 offen offset:2048 nt
    s_add_u32 s20, s17, 24576
    s_cmp_gt_u32 s18, 3
    s_cselect_b32 s20, 0x4000000, s20
    buffer_load_dwordx4 v[108:111], v1, s[8:11], s20 offen offset:0 nt
    s_waitcnt vmcnt(3)
    s_add_u32 s20, s16, 98304
    buffer_load_dwordx4 v[112:115], v1, s[8:11], s20 offen offset:3072 nt
    s_waitcnt vmcnt(3)
    s_add_u32 s20, s16, 131072
    buffer_load_dwordx4 v[116:119], v1, s[8:11], s20 offen offset:0 nt
    s_waitcnt vmcnt(3)
    buffer_load_dwordx4 v[120:123], v1, s[8:11], s20 offen offset:1024 nt
    s_add_u32 s20, s17, 32768
    s_cmp_gt_u32 s18, 4
    s_cselect_b32 s20, 0x4000000, s20
    buffer_load_dwordx4 v[124:127], v1, s[8:11], s20 offen offset:0 nt
    s_waitcnt vmcnt(3)
    s_add_u32 s20, s16, 131072
    buffer_load_dwordx4 v[128:131], v1, s[8:11], s20 offen offset:2048 nt
    s_waitcnt vmcnt(3)
    buffer_load_dwordx4 v[132:135], v1, s[8:11], s20 offen offset:3072 nt
    s_waitcnt vmcnt(3)
    s_add_u32 s20, s16, 163840
    buffer_load_dwordx4 v[136:139], v1, s[8:11], s20 offen offset:0 nt
    s_waitcnt vmcnt(2)
    buffer_load_dwordx4 v[140:143], v1, s[8:11], s20 offen offset:1024 nt
    s_waitcnt vmcnt(2)
    buffer_load_dwordx4 v[144:147], v1, s[8:11], s20 offen offset:2048 nt
    s_waitcnt vmcnt(2)
    buffer_load_dwordx4 v[148:151], v1, s[8:11], s20 offen offset:3072 nt
    s_waitcnt vmcnt(2)
    s_add_u32 s20, s16, 196608
    buffer_load_dwordx4 v[152:155], v1, s[8:11], s20 offen offset:0 nt
    s_waitcnt vmcnt(2)
    buffer_load_dwordx4 v[156:159], v1, s[8:11], s20 offen offset:1024 nt
    s_waitcnt vmcnt(2)
    buffer_load_dwordx4 v[160:163], v1, s[8:11], s20 offen offset:2048 nt
    s_waitcnt vmcnt(2)
    buffer_load_dwordx4 v[164:167], v1, s[8:11], s20 offen offset:3072 nt
    s_waitcnt vmcnt(2)
    s_add_u32 s20, s16, 0
    buffer_load_dwordx4 v[12:15], v2, s[12:15], s20 offen offset:0 nt
    s_waitcnt vmcnt(2)
    buffer_load_dwordx4 v[16:19], v2, s[12:15], s20 offen offset:1024 nt
    s_waitcnt vmcnt(2)
    buffer_load_dwordx4 v[20:23], v2, s[12:15], s20 offen offset:2048 nt
    s_waitcnt vmcnt(2)
    buffer_load_dwordx4 v[24:27], v2, s[12:15], s20 offen offset:3072 nt
    s_waitcnt vmcnt(2)
    s_add_u32 s20, s16, 32768
    buffer_load_dwordx4 v[28:31], v2, s[12:15], s20 offen offset:0 nt
    v_mov_b32 v8, 0
    v_mov_b32 v9, 2
    s_mov_b64 exec, 1
    ds_max_u32 v8, v9 offset:20
    s_mov_b64 exec, -1
    v_and_b32 v8, 3, v0
    v_lshlrev_b32 v8, 8, v8
    v_lshrrev_b32 v9, 4, v0
    v_lshl_add_u32 v8, v9, 6, v8
    v_bfe_u32 v9, v0, 2, 2
    v_lshl_add_u32 v8, v9, 4, v8
    v_mov_b32 v9, 0
    s_mov_b32 s22, 0x3fb8aa3b
    s_mov_b32 s26, 0x3db504f3
    s_mov_b32 s27, s26
    s_cmp_gt_u32 s18, 0
    s_cselect_b32 s28, 0xff800000, 0
    s_cmp_gt_u32 s18, 1
    s_cselect_b32 s29, 0xff800000, 0
    s_cmp_gt_u32 s18, 2
    s_cselect_b32 s30, 0xff800000, 0
    s_cmp_gt_u32 s18, 3
    s_cselect_b32 s31, 0xff800000, 0
    s_cmp_gt_u32 s18, 4
    s_cselect_b32 s32, 0xff800000, 0
    s_mov_b32 s7, 8000000
L_sq_1:
    ds_read_b32 v10, v9 offset:4
    ds_read_b128 v[4:7], v8 offset:1024
    s_waitcnt lgkmcnt(0)
    v_cmp_gt_u32 vcc, 1, v10
    s_cbranch_vccz L_sqd_2
    s_sleep 2
    s_sub_u32 s7, s7, 1
    s_cbranch_scc0 L_sq_1
L_sqd_2:
    v_mfma_f32_16x16x32_bf16 v[8:11], v[32:35], v[4:7], 0
    v_mfma_f32_16x16x32_bf16 v[32:35], v[36:39], v[4:7], 0
    v_mfma_f32_16x16x32_bf16 v[36:39], v[40:43], v[4:7], 0
    s_nop 5
    v_add_f32_dpp v8, v9, v8 row_shl:4 row_mask:0xf bank_mask:0xf bound_ctrl:0
    v_add_f32_dpp v10, v11, v10 row_shl:4 row_mask:0xf bank_mask:0xf bound_ctrl:0
    v_mfma_f32_16x16x32_bf16 v[40:43], v[44:47], v[4:7], 0
    v_add_f32_dpp v32, v33, v32 row_shl:4 row_mask:0xf bank_mask:0xf bound_ctrl:0
    v_add_f32_dpp v34, v35, v34 row_shl:4 row_mask:0xf bank_mask:0xf bound_ctrl:0
    v_add_f32_dpp v8, v10, v8 row_shl:8 row_mask:0xf bank_mask:0xf bound_ctrl:0
    v_mfma_f32_16x16x32_bf16 v[44:47], v[48:51], v[4:7], 0
    v_add_f32_dpp v36, v37, v36 row_shl:4 row_mask:0xf bank_mask:0xf bound_ctrl:0
    v_add_f32_dpp v38, v39, v38 row_shl:4 row_mask:0xf bank_mask:0xf bound_ctrl:0
    v_add_f32_dpp v9, v34, v32 row_shl:8 row_mask:0xf bank_mask:0xf bound_ctrl:0
    v_mfma_f32_16x16x32_bf16 v[48:51], v[52:55], v[4:7], 0
    v_add_f32_dpp v40, v41, v40 row_shl:4 row_mask:0xf bank_mask:0xf bound_ctrl:0
    v_add_f32_dpp v42, v43, v42 row_shl:4 row_mask:0xf bank_mask:0xf bound_ctrl:0
    v_add_f32_dpp v10, v38, v36 row_shl:8 row_mask:0xf bank_mask:0xf bound_ctrl:0
    v_mfma_f32_16x16x32_bf16 v[52:55], v[56:59], v[4:7], 0
    v_add_f32_dpp v44, v45, v44 row_shl:4 row_mask:0xf bank_mask:0xf bound_ctrl:0
    v_add_f32_dpp v46, v47, v46 row_shl:4 row_mask:0xf bank_mask:0xf bound_ctrl:0
    v_add_f32_dpp v11, v42, v40 row_shl:8 row_mask:0xf bank_mask:0xf bound_ctrl:0
    v_mfma_f32_16x16x32_bf16 v[56:59], v[60:63], v[4:7], 0
    v_add_f32_dpp v48, v49, v48 row_shl:4 row_mask:0xf bank_mask:0xf bound_ctrl:0
    v_add_f32_dpp v50, v51, v50 row_shl:4 row_mask:0xf bank_mask:0xf bound_ctrl:0
    v_add_f32_dpp v32, v46, v44 row_shl:8 row_mask:0xf bank_mask:0xf bound_ctrl:0
    v_mfma_f32_16x16x32_bf16 v[60:63], v[64:67], v[4:7], 0
    v_add_f32_dpp v52, v53, v52 row_shl:4 row_mask:0xf bank_mask:0xf bound_ctrl:0
    v_add_f32_dpp v54, v55, v54 row_shl:4 row_mask:0xf bank_mask:0xf bound_ctrl:0
    v_add_f32_dpp v33, v50, v48 row_shl:8 row_mask:0xf bank_mask:0xf bound_ctrl:0
    v_mfma_f32_16x16x32_bf16 v[64:67], v[68:71], v[4:7], 0
    v_add_f32_dpp v56, v57, v56 row_shl:4 row_mask:0xf bank_mask:0xf bound_ctrl:0
    v_add_f32_dpp v58, v59, v58 row_shl:4 row_mask:0xf bank_mask:0xf bound_ctrl:0
    v_add_f32_dpp v34, v54, v52 row_shl:8 row_mask:0xf bank_mask:0xf bound_ctrl:0
    v_mfma_f32_16x16x32_bf16 v[68:71], v[72:75], v[4:7], 0
    v_add_f32_dpp v60, v61, v60 row_shl:4 row_mask:0xf bank_mask:0xf bound_ctrl:0
    v_add_f32_dpp v62, v63, v62 row_shl:4 row_mask:0xf bank_mask:0xf bound_ctrl:0
    v_add_f32_dpp v35, v58, v56 row_shl:8 row_mask:0xf bank_mask:0xf bound_ctrl:0
    v_mfma_f32_16x16x32_bf16 v[72:75], v[76:79], v[4:7], 0
    v_add_f32_dpp v64, v65, v64 row_shl:4 row_mask:0xf bank_mask:0xf bound_ctrl:0
    v_add_f32_dpp v66, v67, v66 row_shl:4 row_mask:0xf bank_mask:0xf bound_ctrl:0
    v_add_f32_dpp v36, v62, v60 row_shl:8 row_mask:0xf bank_mask:0xf bound_ctrl:0
    v_mfma_f32_16x16x32_bf16 v[76:79], v[80:83], v[4:7], 0
    v_add_f32_dpp v68, v69, v68 row_shl:4 row_mask:0xf bank_mask:0xf bound_ctrl:0
    v_add_f32_dpp v70, v71, v70 row_shl:4 row_mask:0xf bank_mask:0xf bound_ctrl:0
    v_add_f32_dpp v37, v66, v64 row_shl:8 row_mask:0xf bank_mask:0xf bound_ctrl:0
    v_mfma_f32_16x16x32_bf16 v[80:83], v[84:87], v[4:7], 0
    v_add_f32_dpp v72, v73, v72 row_shl:4 row_mask:0xf bank_mask:0xf bound_ctrl:0
    v_add_f32_dpp v74, v75, v74 row_shl:4 row_mask:0xf bank_mask:0xf bound_ctrl:0
    v_add_f32_dpp v38, v70, v68 row_shl:8 row_mask:0xf bank_mask:0xf bound_ctrl:0
    v_mfma_f32_16x16x32_bf16 v[84:87], v[88:91], v[4:7], 0
    v_add_f32_dpp v76, v77, v76 row_shl:4 row_mask:0xf bank_mask:0xf bound_ctrl:0
    v_add_f32_dpp v78, v79, v78 row_shl:4 row_mask:0xf bank_mask:0xf bound_ctrl:0
    v_add_f32_dpp v39, v74, v72 row_shl:8 row_mask:0xf bank_mask:0xf bound_ctrl:0
    v_mfma_f32_16x16x32_bf16 v[88:91], v[92:95], v[4:7], 0
    v_add_f32_dpp v80, v81, v80 row_shl:4 row_mask:0xf bank_mask:0xf bound_ctrl:0
    v_add_f32_dpp v82, v83, v82 row_shl:4 row_mask:0xf bank_mask:0xf bound_ctrl:0
    v_add_f32_dpp v40, v78, v76 row_shl:8 row_mask:0xf bank_mask:0xf bound_ctrl:0
    v_mfma_f32_16x16x32_bf16 v[92:95], v[96:99], v[4:7], 0
    v_add_f32_dpp v84, v85, v84 row_shl:4 row_mask:0xf bank_mask:0xf bound_ctrl:0
    v_add_f32_dpp v86, v87, v86 row_shl:4 row_mask:0xf bank_mask:0xf bound_ctrl:0
    v_add_f32_dpp v41, v82, v80 row_shl:8 row_mask:0xf bank_mask:0xf bound_ctrl:0
    v_mfma_f32_16x16x32_bf16 v[96:99], v[100:103], v[4:7], 0
    v_add_f32_dpp v88, v89, v88 row_shl:4 row_mask:0xf bank_mask:0xf bound_ctrl:0
    v_add_f32_dpp v90, v91, v90 row_shl:4 row_mask:0xf bank_mask:0xf bound_ctrl:0
    v_add_f32_dpp v42, v86, v84 row_shl:8 row_mask:0xf bank_mask:0xf bound_ctrl:0
    v_mfma_f32_16x16x32_bf16 v[100:103], v[104:107], v[4:7], 0
    v_add_f32_dpp v92, v93, v92 row_shl:4 row_mask:0xf bank_mask:0xf bound_ctrl:0
    v_add_f32_dpp v94, v95, v94 row_shl:4 row_mask:0xf bank_mask:0xf bound_ctrl:0
    v_add_f32_dpp v43, v90, v88 row_shl:8 row_mask:0xf bank_mask:0xf bound_ctrl:0
    buffer_load_dwordx4 v[88:91], v2, s[12:15], s20 offen offset:1024 nt
    v_mfma_f32_16x16x32_bf16 v[104:107], v[108:111], v[4:7], 0
    v_add_f32_dpp v96, v97, v96 row_shl:4 row_mask:0xf bank_mask:0xf bound_ctrl:0
    v_add_f32_dpp v98, v99, v98 row_shl:4 row_mask:0xf bank_mask:0xf bound_ctrl:0
    v_add_f32_dpp v44, v94, v92 row_shl:8 row_mask:0xf bank_mask:0xf bound_ctrl:0
    v_mfma_f32_16x16x32_bf16 v[108:111], v[112:115], v[4:7], 0
    v_add_f32_dpp v100, v101, v100 row_shl:4 row_mask:0xf bank_mask:0xf bound_ctrl:0
    v_add_f32_dpp v102, v103, v102 row_shl:4 row_mask:0xf bank_mask:0xf bound_ctrl:0
    v_add_f32_dpp v45, v98, v96 row_shl:8 row_mask:0xf bank_mask:0xf bound_ctrl:0
    v_mfma_f32_16x16x32_bf16 v[112:115], v[116:119], v[4:7], 0
    v_add_f32_dpp v104, v105, v104 row_shl:4 row_mask:0xf bank_mask:0xf bound_ctrl:0
    v_add_f32_dpp v106, v107, v106 row_shl:4 row_mask:0xf bank_mask:0xf bound_ctrl:0
    v_add_f32_dpp v46, v102, v100 row_shl:8 row_mask:0xf bank_mask:0xf bound_ctrl:0
    v_mfma_f32_16x16x32_bf16 v[116:119], v[120:123], v[4:7], 0
    v_add_f32_dpp v108, v109, v108 row_shl:4 row_mask:0xf bank_mask:0xf bound_ctrl:0
    v_add_f32_dpp v110, v111, v110 row_shl:4 row_mask:0xf bank_mask:0xf bound_ctrl:0
    v_add_f32_dpp v47, v106, v104 row_shl:8 row_mask:0xf bank_mask:0xf bound_ctrl:0
    v_mfma_f32_16x16x32_bf16 v[120:123], v[124:127], v[4:7], 0
    v_add_f32_dpp v112, v113, v112 row_shl:4 row_mask:0xf bank_mask:0xf bound_ctrl:0
    v_add_f32_dpp v114, v115, v114 row_shl:4 row_mask:0xf bank_mask:0xf bound_ctrl:0
    v_add_f32_dpp v48, v110, v108 row_shl:8 row_mask:0xf bank_mask:0xf bound_ctrl:0
    v_mfma_f32_16x16x32_bf16 v[124:127], v[128:131], v[4:7], 0
    v_add_f32_dpp v116, v117, v116 row_shl:4 row_mask:0xf bank_mask:0xf bound_ctrl:0
    v_add_f32_dpp v118, v119, v118 row_shl:4 row_mask:0xf bank_mask:0xf bound_ctrl:0
    v_add_f32_dpp v49, v114, v112 row_shl:8 row_mask:0xf bank_mask:0xf bound_ctrl:0
    v_mfma_f32_16x16x32_bf16 v[128:131], v[132:135], v[4:7], 0
    v_add_f32_dpp v120, v121, v120 row_shl:4 row_mask:0xf bank_mask:0xf bound_ctrl:0
    v_add_f32_dpp v122, v123, v122 row_shl:4 row_mask:0xf bank_mask:0xf bound_ctrl:0
    v_add_f32_dpp v50, v118, v116 row_shl:8 row_mask:0xf bank_mask:0xf bound_ctrl:0
    v_mfma_f32_16x16x32_bf16 v[132:135], v[136:139], v[4:7], 0
    v_add_f32_dpp v124, v125, v124 row_shl:4 row_mask:0xf bank_mask:0xf bound_ctrl:0
    v_add_f32_dpp v126, v127, v126 row_shl:4 row_mask:0xf bank_mask:0xf bound_ctrl:0
    v_add_f32_dpp v51, v122, v120 row_shl:8 row_mask:0xf bank_mask:0xf bound_ctrl:0
    s_add_u32 s20, s17, 0
    s_cmp_gt_u32 s18, 0
    s_cselect_b32 s20, 0x4000000, s20
    buffer_load_dwordx4 v[92:95], v2, s[12:15], s20 offen offset:0 nt
    v_mfma_f32_16x16x32_bf16 v[136:139], v[140:143], v[4:7], 0
    v_add_f32_dpp v128, v129, v128 row_shl:4 row_mask:0xf bank_mask:0xf bound_ctrl:0
    v_add_f32_dpp v130, v131, v130 row_shl:4 row_mask:0xf bank_mask:0xf bound_ctrl:0
    v_add_f32_dpp v52, v126, v124 row_shl:8 row_mask:0xf bank_mask:0xf bound_ctrl:0
    v_mfma_f32_16x16x32_bf16 v[140:143], v[144:147], v[4:7], 0
    v_add_f32_dpp v132, v133, v132 row_shl:4 row_mask:0xf bank_mask:0xf bound_ctrl:0
    v_add_f32_dpp v134, v135, v134 row_shl:4 row_mask:0xf bank_mask:0xf bound_ctrl:0
    v_add_f32_dpp v53, v130, v128 row_shl:8 row_mask:0xf bank_mask:0xf bound_ctrl:0
    v_mfma_f32_16x16x32_bf16 v[144:147], v[148:151], v[4:7], 0
    v_add_f32_dpp v136, v137, v136 row_shl:4 row_mask:0xf bank_mask:0xf bound_ctrl:0
    v_add_f32_dpp v138, v139, v138 row_shl:4 row_mask:0xf bank_mask:0xf bound_ctrl:0
    v_add_f32_dpp v54, v134, v132 row_shl:8 row_mask:0xf bank_mask:0xf bound_ctrl:0
    v_mfma_f32_16x16x32_bf16 v[148:151], v[152:155], v[4:7], 0
    v_add_f32_dpp v140, v141, v140 row_shl:4 row_mask:0xf bank_mask:0xf bound_ctrl:0
    v_add_f32_dpp v142, v143, v142 row_shl:4 row_mask:0xf bank_mask:0xf bound_ctrl:0
    v_add_f32_dpp v55, v138, v136 row_shl:8 row_mask:0xf bank_mask:0xf bound_ctrl:0
    v_mfma_f32_16x16x32_bf16 v[152:155], v[156:159], v[4:7], 0
    v_add_f32_dpp v144, v145, v144 row_shl:4 row_mask:0xf bank_mask:0xf bound_ctrl:0
    v_add_f32_dpp v146, v147, v146 row_shl:4 row_mask:0xf bank_mask:0xf bound_ctrl:0
    v_add_f32_dpp v56, v142, v140 row_shl:8 row_mask:0xf bank_mask:0xf bound_ctrl:0
    v_mfma_f32_16x16x32_bf16 v[156:159], v[160:163], v[4:7], 0
    v_add_f32_dpp v148, v149, v148 row_shl:4 row_mask:0xf bank_mask:0xf bound_ctrl:0
    v_add_f32_dpp v150, v151, v150 row_shl:4 row_mask:0xf bank_mask:0xf bound_ctrl:0
    v_add_f32_dpp v57, v146, v144 row_shl:8 row_mask:0xf bank_mask:0xf bound_ctrl:0
    s_waitcnt vmcnt(7)
    v_mfma_f32_16x16x32_bf16 v[160:163], v[164:167], v[4:7], 0
    v_add_f32_dpp v152, v153, v152 row_shl:4 row_mask:0xf bank_mask:0xf bound_ctrl:0
    v_add_f32_dpp v154, v155, v154 row_shl:4 row_mask:0xf bank_mask:0xf bound_ctrl:0
    v_add_f32_dpp v58, v150, v148 row_shl:8 row_mask:0xf bank_mask:0xf bound_ctrl:0
    v_add_f32_dpp v156, v157, v156 row_shl:4 row_mask:0xf bank_mask:0xf bound_ctrl:0
    v_add_f32_dpp v158, v159, v158 row_shl:4 row_mask:0xf bank_mask:0xf bound_ctrl:0
    v_add_f32_dpp v59, v154, v152 row_shl:8 row_mask:0xf bank_mask:0xf bound_ctrl:0
    s_add_u32 s20, s17, 40960
    buffer_load_dwordx4 v[96:99], v2, s[12:15], s20 offen offset:0 nt
    v_add_f32_dpp v160, v161, v160 row_shl:4 row_mask:0xf bank_mask:0xf bound_ctrl:0
    v_add_f32_dpp v162, v163, v162 row_shl:4 row_mask:0xf bank_mask:0xf bound_ctrl:0
    v_add_f32_dpp v60, v158, v156 row_shl:8 row_mask:0xf bank_mask:0xf bound_ctrl:0
    s_nop 0
    v_add_f32_dpp v61, v162, v160 row_shl:8 row_mask:0xf bank_mask:0xf bound_ctrl:0
    v_cvt_pk_bf16_f32 v9, v8, v9
    v_lshlrev_b32 v8, 16, v9
    v_and_b32 v9, 0xffff0000, v9
    v_cvt_pk_bf16_f32 v11, v10, v11
    v_lshlrev_b32 v10, 16, v11
    v_and_b32 v11, 0xffff0000, v11
    v_cvt_pk_bf16_f32 v33, v32, v33
    v_lshlrev_b32 v32, 16, v33
    v_and_b32 v33, 0xffff0000, v33
    v_cvt_pk_bf16_f32 v35, v34, v35
    v_lshlrev_b32 v34, 16, v35
    v_and_b32 v35, 0xffff0000, v35
    v_cvt_pk_bf16_f32 v37, v36, v37
    v_lshlrev_b32 v36, 16, v37
    v_and_b32 v37, 0xffff0000, v37
    v_cvt_pk_bf16_f32 v39, v38, v39
    v_lshlrev_b32 v38, 16, v39
    v_and_b32 v39, 0xffff0000, v39
    v_cvt_pk_bf16_f32 v41, v40, v41
    v_lshlrev_b32 v40, 16, v41
    v_and_b32 v41, 0xffff0000, v41
    v_cvt_pk_bf16_f32 v43, v42, v43
    v_lshlrev_b32 v42, 16, v43
    v_and_b32 v43, 0xffff0000, v43
    v_cvt_pk_bf16_f32 v45, v44, v45
    v_lshlrev_b32 v44, 16, v45
    v_and_b32 v45, 0xffff0000, v45
    v_cvt_pk_bf16_f32 v47, v46, v47
    v_lshlrev_b32 v46, 16, v47
    v_and_b32 v47, 0xffff0000, v47
    v_cvt_pk_bf16_f32 v49, v48, v49
    v_lshlrev_b32 v48, 16, v49
    v_and_b32 v49, 0xffff0000, v49
    v_cvt_pk_bf16_f32 v51, v50, v51
    v_lshlrev_b32 v50, 16, v51
    v_and_b32 v51, 0xffff0000, v51
    v_cvt_pk_bf16_f32 v53, v52, v53
    v_lshlrev_b32 v52, 16, v53
    v_and_b32 v53, 0xffff0000, v53
    v_cvt_pk_bf16_f32 v55, v54, v55
    v_lshlrev_b32 v54, 16, v55
    v_and_b32 v55, 0xffff0000, v55
    v_cvt_pk_bf16_f32 v57, v56, v57
    v_lshlrev_b32 v56, 16, v57
    v_and_b32 v57, 0xffff0000, v57
    v_cvt_pk_bf16_f32 v59, v58, v59
    v_lshlrev_b32 v58, 16, v59
    v_and_b32 v59, 0xffff0000, v59
    v_cvt_pk_bf16_f32 v61, v60, v61
    v_lshlrev_b32 v60, 16, v61
    v_and_b32 v61, 0xffff0000, v61
    v_pk_mul_f32 v[8:9], v[8:9], s[26:27]
    v_pk_mul_f32 v[10:11], v[10:11], s[26:27]
    v_pk_mul_f32 v[32:33], v[32:33], s[26:27]
    v_pk_mul_f32 v[34:35], v[34:35], s[26:27]
    v_pk_mul_f32 v[36:37], v[36:37], s[26:27]
    v_pk_mul_f32 v[38:39], v[38:39], s[26:27]
    v_pk_mul_f32 v[40:41], v[40:41], s[26:27]
    v_pk_mul_f32 v[42:43], v[42:43], s[26:27]
    v_pk_mul_f32 v[44:45], v[44:45], s[26:27]
    v_pk_mul_f32 v[46:47], v[46:47], s[26:27]
    v_pk_mul_f32 v[48:49], v[48:49], s[26:27]
    v_pk_mul_f32 v[50:51], v[50:51], s[26:27]
    v_pk_mul_f32 v[52:53], v[52:53], s[26:27]
    v_pk_mul_f32 v[54:55], v[54:55], s[26:27]
    v_pk_mul_f32 v[56:57], v[56:57], s[26:27]
    v_pk_mul_f32 v[58:59], v[58:59], s[26:27]
    v_pk_mul_f32 v[60:61], v[60:61], s[26:27]
    s_add_u32 s20, s16, 32768
    buffer_load_dwordx4 v[100:103], v2, s[12:15], s20 offen offset:2048 nt
    v_cvt_pk_bf16_f32 v9, v8, v9
    v_lshlrev_b32 v8, 16, v9
    v_and_b32 v9, 0xffff0000, v9
    v_cvt_pk_bf16_f32 v11, v10, v11
    v_lshlrev_b32 v10, 16, v11
    v_and_b32 v11, 0xffff0000, v11
    v_cvt_pk_bf16_f32 v33, v32, v33
    v_lshlrev_b32 v32, 16, v33
    v_and_b32 v33, 0xffff0000, v33
    v_cvt_pk_bf16_f32 v35, v34, v35
    v_lshlrev_b32 v34, 16, v35
    v_and_b32 v35, 0xffff0000, v35
    v_cvt_pk_bf16_f32 v37, v36, v37
    v_lshlrev_b32 v36, 16, v37
    v_and_b32 v37, 0xffff0000, v37
    v_cvt_pk_bf16_f32 v39, v38, v39
    v_lshlrev_b32 v38, 16, v39
    v_and_b32 v39, 0xffff0000, v39
    v_cvt_pk_bf16_f32 v41, v40, v41
    v_lshlrev_b32 v40, 16, v41
    v_and_b32 v41, 0xffff0000, v41
    v_cvt_pk_bf16_f32 v43, v42, v43
    v_lshlrev_b32 v42, 16, v43
    v_and_b32 v43, 0xffff0000, v43
    v_cvt_pk_bf16_f32 v45, v44, v45
    v_lshlrev_b32 v44, 16, v45
    v_and_b32 v45, 0xffff0000, v45
    v_cvt_pk_bf16_f32 v47, v46, v47
    v_lshlrev_b32 v46, 16, v47
    v_and_b32 v47, 0xffff0000, v47
    v_cvt_pk_bf16_f32 v49, v48, v49
    v_lshlrev_b32 v48, 16, v49
    v_and_b32 v49, 0xffff0000, v49
    v_cvt_pk_bf16_f32 v51, v50, v51
    v_lshlrev_b32 v50, 16, v51
    v_and_b32 v51, 0xffff0000, v51
    v_cvt_pk_bf16_f32 v53, v52, v53
    v_lshlrev_b32 v52, 16, v53
    v_and_b32 v53, 0xffff0000, v53
    v_cvt_pk_bf16_f32 v55, v54, v55
    v_lshlrev_b32 v54, 16, v55
    v_and_b32 v55, 0xffff0000, v55
    v_cvt_pk_bf16_f32 v57, v56, v57
    v_lshlrev_b32 v56, 16, v57
    v_and_b32 v57, 0xffff0000, v57
    v_cvt_pk_bf16_f32 v59, v58, v59
    v_lshlrev_b32 v58, 16, v59
    v_and_b32 v59, 0xffff0000, v59
    v_cvt_pk_bf16_f32 v61, v60, v61
    v_lshlrev_b32 v60, 16, v61
    v_and_b32 v61, 0xffff0000, v61
    v_add_f32 v34, s28, v34
    v_add_f32 v38, s29, v38
    v_add_f32 v42, s30, v42
    v_add_f32 v47, s31, v47
    v_add_f32 v51, s32, v51
    v_max3_f32 v76, v8, v9, v10
    v_max3_f32 v77, v11, v32, v33
    v_max3_f32 v76, v76, v34, v35
    v_max3_f32 v77, v77, v36, v37
    v_max3_f32 v76, v76, v38, v39
    v_max3_f32 v77, v77, v40, v41
    v_max3_f32 v76, v76, v42, v43
    v_max3_f32 v77, v77, v44, v45
    v_max3_f32 v76, v76, v46, v47
    v_max3_f32 v77, v77, v48, v49
    v_max3_f32 v76, v76, v50, v51
    v_max3_f32 v77, v77, v52, v53
    v_max3_f32 v76, v76, v54, v55
    v_max3_f32 v77, v77, v56, v57
    v_max3_f32 v76, v76, v58, v59
    v_max3_f32 v77, v77, v60, v61
    v_max_f32 v76, v76, v77
    v_mov_b32 v77, v76
    s_nop 1
    v_permlane16_swap_b32 v76, v77
    v_max_f32 v76, v76, v77
    v_mov_b32 v77, v76
    s_nop 1
    v_permlane32_swap_b32 v76, v77
    v_max_f32 v76, v76, v77
    v_mul_f32 v76, s22, v76
    v_fma_f32 v8, v8, s22, -v76
    v_fma_f32 v9, v9, s22, -v76
    v_fma_f32 v10, v10, s22, -v76
    v_fma_f32 v11, v11, s22, -v76
    v_fma_f32 v32, v32, s22, -v76
    v_fma_f32 v33, v33, s22, -v76
    v_fma_f32 v34, v34, s22, -v76
    v_fma_f32 v35, v35, s22, -v76
    v_fma_f32 v36, v36, s22, -v76
    v_fma_f32 v37, v37, s22, -v76
    v_fma_f32 v38, v38, s22, -v76
    v_fma_f32 v39, v39, s22, -v76
    v_fma_f32 v40, v40, s22, -v76
    v_fma_f32 v41, v41, s22, -v76
    v_fma_f32 v42, v42, s22, -v76
    v_fma_f32 v43, v43, s22, -v76
    v_fma_f32 v44, v44, s22, -v76
    v_fma_f32 v45, v45, s22, -v76
    v_fma_f32 v46, v46, s22, -v76
    v_fma_f32 v47, v47, s22, -v76
    v_fma_f32 v48, v48, s22, -v76
    v_fma_f32 v49, v49, s22, -v76
    v_fma_f32 v50, v50, s22, -v76
    v_fma_f32 v51, v51, s22, -v76
    v_fma_f32 v52, v52, s22, -v76
    v_fma_f32 v53, v53, s22, -v76
    v_fma_f32 v54, v54, s22, -v76
    v_fma_f32 v55, v55, s22, -v76
    v_fma_f32 v56, v56, s22, -v76
    v_fma_f32 v57, v57, s22, -v76
    v_fma_f32 v58, v58, s22, -v76
    v_fma_f32 v59, v59, s22, -v76
    v_fma_f32 v60, v60, s22, -v76
    v_fma_f32 v61, v61, s22, -v76
    v_exp_f32 v8, v8
    v_exp_f32 v9, v9
    v_exp_f32 v10, v10
    v_exp_f32 v11, v11
    v_exp_f32 v32, v32
    v_exp_f32 v33, v33
    v_exp_f32 v34, v34
    v_exp_f32 v35, v35
    v_exp_f32 v36, v36
    v_exp_f32 v37, v37
    v_exp_f32 v38, v38
    v_exp_f32 v39, v39
    v_exp_f32 v40, v40
    v_exp_f32 v41, v41
    v_exp_f32 v42, v42
    v_exp_f32 v43, v43
    v_exp_f32 v44, v44
    v_exp_f32 v45, v45
    v_exp_f32 v46, v46
    v_exp_f32 v47, v47
    v_exp_f32 v48, v48
    v_exp_f32 v49, v49
    v_exp_f32 v50, v50
    v_exp_f32 v51, v51
    v_exp_f32 v52, v52
    v_exp_f32 v53, v53
    v_exp_f32 v54, v54
    v_exp_f32 v55, v55
    v_exp_f32 v56, v56
    v_exp_f32 v57, v57
    v_exp_f32 v58, v58
    v_exp_f32 v59, v59
    v_exp_f32 v60, v60
    v_exp_f32 v61, v61
    buffer_load_dwordx4 v[104:107], v2, s[12:15], s20 offen offset:3072 nt
    v_add_f32 v77, v8, v9
    v_add_f32 v78, v10, v11
    v_add_f32 v77, v77, v32
    v_add_f32 v78, v78, v33
    v_add_f32 v77, v77, v34
    v_add_f32 v78, v78, v35
    v_add_f32 v77, v77, v36
    v_add_f32 v78, v78, v37
    v_add_f32 v77, v77, v38
    v_add_f32 v78, v78, v39
    v_add_f32 v77, v77, v40
    v_add_f32 v78, v78, v41
    v_add_f32 v77, v77, v42
    v_add_f32 v78, v78, v43
    v_add_f32 v77, v77, v44
    v_add_f32 v78, v78, v45
    v_add_f32 v77, v77, v46
    v_add_f32 v78, v78, v47
    v_add_f32 v77, v77, v48
    v_add_f32 v78, v78, v49
    v_add_f32 v77, v77, v50
    v_add_f32 v78, v78, v51
    v_add_f32 v77, v77, v52
    v_add_f32 v78, v78, v53
    v_add_f32 v77, v77, v54
    v_add_f32 v78, v78, v55
    v_add_f32 v77, v77, v56
    v_add_f32 v78, v78, v57
    v_add_f32 v77, v77, v58
    v_add_f32 v78, v78, v59
    v_add_f32 v77, v77, v60
    v_add_f32 v78, v78, v61
    v_add_f32 v77, v77, v78
    v_mov_b32 v78, v77
    s_nop 1
    v_permlane16_swap_b32 v77, v78
    v_add_f32 v77, v77, v78
    v_mov_b32 v78, v77
    s_nop 1
    v_permlane32_swap_b32 v77, v78
    v_add_f32 v77, v77, v78
    s_lshl_b32 s19, s21, 5
    v_lshl_add_u32 v78, v0, 3, s19
    v_mov_b32 v4, 0
    v_mov_b32 v5, 1
    s_mov_b64 exec, 0xf
    ds_write_b64 v78, v[76:77] offset:256
    s_mov_b64 exec, 1
    ds_add_u32 v4, v5 offset:8
    s_mov_b64 exec, -1
    v_cvt_pk_bf16_f32 v64, v8, v9
    v_cvt_pk_bf16_f32 v68, v10, v11
    v_cvt_pk_bf16_f32 v69, v32, v33
    v_cvt_pk_bf16_f32 v70, v34, v35
    v_cvt_pk_bf16_f32 v71, v36, v37
    v_cvt_pk_bf16_f32 v72, v38, v39
    v_cvt_pk_bf16_f32 v73, v40, v41
    v_cvt_pk_bf16_f32 v74, v42, v43
    v_cvt_pk_bf16_f32 v75, v44, v45
    s_waitcnt lgkmcnt(0)
    v_mov_b32 v36, 0
    v_mov_b32 v37, 0
    v_mov_b32 v38, 0
    v_mov_b32 v39, 0
    v_mov_b32 v40, 0
    v_mov_b32 v41, 0
    v_mov_b32 v42, 0
    v_mov_b32 v43, 0
    v_mov_b32 v80, 0
    v_mov_b32 v81, 0
    v_mov_b32 v82, 0
    v_mov_b32 v83, 0
    v_mov_b32 v84, 0
    v_mov_b32 v85, 0
    v_mov_b32 v86, 0
    v_mov_b32 v87, 0
    v_mov_b32 v77, 0
    v_mov_b32 v5, 0
    s_waitcnt vmcnt(8)
    v_mov_b32_dpp v36, v64 quad_perm:[0,1,2,3] row_mask:0xf bank_mask:0x1
    v_mov_b32_dpp v40, v64 row_shr:4 row_mask:0xf bank_mask:0x2
    v_mov_b32_dpp v80, v64 row_shr:8 row_mask:0xf bank_mask:0x4
    v_mov_b32_dpp v84, v64 row_shr:12 row_mask:0xf bank_mask:0x8
    v_perm_b32 v76, v16, v12, s24
    s_nop 1
    v_mfma_f32_16x16x16_bf16 v[8:11], v[76:77], v[36:37], 0
    v_perm_b32 v4, v18, v14, s24
    s_nop 1
    v_mfma_f32_16x16x16_bf16 v[32:35], v[4:5], v[36:37], 0
    v_perm_b32 v76, v16, v12, s25
    s_nop 1
    v_mfma_f32_16x16x16_bf16 v[8:11], v[76:77], v[40:41], v[8:11]
    v_perm_b32 v4, v18, v14, s25
    s_nop 1
    v_mfma_f32_16x16x16_bf16 v[32:35], v[4:5], v[40:41], v[32:35]
    v_perm_b32 v76, v17, v13, s24
    s_nop 1
    v_mfma_f32_16x16x16_bf16 v[8:11], v[76:77], v[80:81], v[8:11]
    v_perm_b32 v4, v19, v15, s24
    s_nop 1
    v_mfma_f32_16x16x16_bf16 v[32:35], v[4:5], v[80:81], v[32:35]
    v_perm_b32 v76, v17, v13, s25
    s_nop 1
    v_mfma_f32_16x16x16_bf16 v[8:11], v[76:77], v[84:85], v[8:11]
    v_perm_b32 v4, v19, v15, s25
    s_nop 1
    v_mfma_f32_16x16x16_bf16 v[32:35], v[4:5], v[84:85], v[32:35]
    s_waitcnt vmcnt(4)
    s_add_u32 s20, s17, 8192
    s_cmp_gt_u32 s18, 1
    s_cselect_b32 s20, 0x4000000, s20
    buffer_load_dwordx4 v[108:111], v2, s[12:15], s20 offen offset:0 nt
    s_waitcnt vmcnt(3)
    s_add_u32 s20, s16, 65536
    buffer_load_dwordx4 v[112:115], v2, s[12:15], s20 offen offset:0 nt
    s_waitcnt vmcnt(3)
    buffer_load_dwordx4 v[116:119], v2, s[12:15], s20 offen offset:1024 nt
    s_waitcnt vmcnt(3)
    buffer_load_dwordx4 v[120:123], v2, s[12:15], s20 offen offset:2048 nt
    s_add_u32 s20, s17, 16384
    s_cmp_gt_u32 s18, 2
    s_cselect_b32 s20, 0x4000000, s20
    buffer_load_dwordx4 v[124:127], v2, s[12:15], s20 offen offset:0 nt
    s_add_u32 s20, s16, 65536
    buffer_load_dwordx4 v[128:131], v2, s[12:15], s20 offen offset:3072 nt
    v_mov_b32_dpp v36, v68 quad_perm:[0,1,2,3] row_mask:0xf bank_mask:0x1
    v_mov_b32_dpp v37, v69 quad_perm:[0,1,2,3] row_mask:0xf bank_mask:0x1
    v_mov_b32_dpp v38, v70 quad_perm:[0,1,2,3] row_mask:0xf bank_mask:0x1
    v_mov_b32_dpp v39, v71 quad_perm:[0,1,2,3] row_mask:0xf bank_mask:0x1
    v_mov_b32_dpp v40, v68 row_shr:4 row_mask:0xf bank_mask:0x2
    v_mov_b32_dpp v41, v69 row_shr:4 row_mask:0xf bank_mask:0x2
    v_mov_b32_dpp v42, v70 row_shr:4 row_mask:0xf bank_mask:0x2
    v_mov_b32_dpp v43, v71 row_shr:4 row_mask:0xf bank_mask:0x2
    v_mov_b32_dpp v80, v68 row_shr:8 row_mask:0xf bank_mask:0x4
    v_mov_b32_dpp v81, v69 row_shr:8 row_mask:0xf bank_mask:0x4
    v_mov_b32_dpp v82, v70 row_shr:8 row_mask:0xf bank_mask:0x4
    v_mov_b32_dpp v83, v71 row_shr:8 row_mask:0xf bank_mask:0x4
    v_mov_b32_dpp v84, v68 row_shr:12 row_mask:0xf bank_mask:0x8
    v_mov_b32_dpp v85, v69 row_shr:12 row_mask:0xf bank_mask:0x8
    v_mov_b32_dpp v86, v70 row_shr:12 row_mask:0xf bank_mask:0x8
    v_mov_b32_dpp v87, v71 row_shr:12 row_mask:0xf bank_mask:0x8
    v_perm_b32 v76, v24, v20, s24
    v_perm_b32 v77, v88, v28, s24
    v_perm_b32 v78, v96, v92, s24
    v_perm_b32 v79, v104, v100, s24
    s_nop 1
    v_mfma_f32_16x16x32_bf16 v[8:11], v[76:79], v[36:39], v[8:11]
    v_perm_b32 v4, v26, v22, s24
    v_perm_b32 v5, v90, v30, s24
    v_perm_b32 v6, v98, v94, s24
    v_perm_b32 v7, v106, v102, s24
    s_nop 1
    v_mfma_f32_16x16x32_bf16 v[32:35], v[4:7], v[36:39], v[32:35]
    v_perm_b32 v76, v24, v20, s25
    v_perm_b32 v77, v88, v28, s25
    v_perm_b32 v78, v96, v92, s25
    v_perm_b32 v79, v104, v100, s25
    s_nop 1
    v_mfma_f32_16x16x32_bf16 v[8:11], v[76:79], v[40:43], v[8:11]
    v_perm_b32 v4, v26, v22, s25
    v_perm_b32 v5, v90, v30, s25
    v_perm_b32 v6, v98, v94, s25
    v_perm_b32 v7, v106, v102, s25
    s_nop 1
    v_mfma_f32_16x16x32_bf16 v[32:35], v[4:7], v[40:43], v[32:35]
    v_perm_b32 v76, v25, v21, s24
    v_perm_b32 v77, v89, v29, s24
    v_perm_b32 v78, v97, v93, s24
    v_perm_b32 v79, v105, v101, s24
    s_nop 1
    v_mfma_f32_16x16x32_bf16 v[8:11], v[76:79], v[80:83], v[8:11]
    v_perm_b32 v4, v27, v23, s24
    v_perm_b32 v5, v91, v31, s24
    v_perm_b32 v6, v99, v95, s24
    v_perm_b32 v7, v107, v103, s24
    s_nop 1
    v_mfma_f32_16x16x32_bf16 v[32:35], v[4:7], v[80:83], v[32:35]
    v_perm_b32 v76, v25, v21, s25
    v_perm_b32 v77, v89, v29, s25
    v_perm_b32 v78, v97, v93, s25
    v_perm_b32 v79, v105, v101, s25
    s_nop 1
    v_mfma_f32_16x16x32_bf16 v[8:11], v[76:79], v[84:87], v[8:11]
    v_perm_b32 v4, v27, v23, s25
    v_perm_b32 v5, v91, v31, s25
    v_perm_b32 v6, v99, v95, s25
    v_perm_b32 v7, v107, v103, s25
    s_nop 1
    v_mfma_f32_16x16x32_bf16 v[32:35], v[4:7], v[84:87], v[32:35]
    s_waitcnt vmcnt(3)
    s_add_u32 s20, s16, 98304
    buffer_load_dwordx4 v[132:135], v2, s[12:15], s20 offen offset:0 nt
    s_waitcnt vmcnt(3)
    buffer_load_dwordx4 v[136:139], v2, s[12:15], s20 offen offset:1024 nt
    s_waitcnt vmcnt(2)
    buffer_load_dwordx4 v[140:143], v2, s[12:15], s20 offen offset:2048 nt
    s_add_u32 s20, s17, 24576
    s_cmp_gt_u32 s18, 3
    s_cselect_b32 s20, 0x4000000, s20
    buffer_load_dwordx4 v[144:147], v2, s[12:15], s20 offen offset:0 nt
    s_waitcnt vmcnt(3)
    s_add_u32 s20, s16, 98304
    buffer_load_dwordx4 v[148:151], v2, s[12:15], s20 offen offset:3072 nt
    s_waitcnt vmcnt(3)
    s_add_u32 s20, s16, 131072
    buffer_load_dwordx4 v[152:155], v2, s[12:15], s20 offen offset:0 nt
    buffer_load_dwordx4 v[156:159], v2, s[12:15], s20 offen offset:1024 nt
    s_add_u32 s20, s17, 32768
    s_cmp_gt_u32 s18, 4
    s_cselect_b32 s20, 0x4000000, s20
    buffer_load_dwordx4 v[160:163], v2, s[12:15], s20 offen offset:0 nt
    v_mov_b32_dpp v36, v72 quad_perm:[0,1,2,3] row_mask:0xf bank_mask:0x1
    v_mov_b32_dpp v37, v73 quad_perm:[0,1,2,3] row_mask:0xf bank_mask:0x1
    v_mov_b32_dpp v38, v74 quad_perm:[0,1,2,3] row_mask:0xf bank_mask:0x1
    v_mov_b32_dpp v39, v75 quad_perm:[0,1,2,3] row_mask:0xf bank_mask:0x1
    v_mov_b32_dpp v40, v72 row_shr:4 row_mask:0xf bank_mask:0x2
    v_mov_b32_dpp v41, v73 row_shr:4 row_mask:0xf bank_mask:0x2
    v_mov_b32_dpp v42, v74 row_shr:4 row_mask:0xf bank_mask:0x2
    v_mov_b32_dpp v43, v75 row_shr:4 row_mask:0xf bank_mask:0x2
    v_mov_b32_dpp v80, v72 row_shr:8 row_mask:0xf bank_mask:0x4
    v_mov_b32_dpp v81, v73 row_shr:8 row_mask:0xf bank_mask:0x4
    v_mov_b32_dpp v82, v74 row_shr:8 row_mask:0xf bank_mask:0x4
    v_mov_b32_dpp v83, v75 row_shr:8 row_mask:0xf bank_mask:0x4
    v_mov_b32_dpp v84, v72 row_shr:12 row_mask:0xf bank_mask:0x8
    v_mov_b32_dpp v85, v73 row_shr:12 row_mask:0xf bank_mask:0x8
    v_mov_b32_dpp v86, v74 row_shr:12 row_mask:0xf bank_mask:0x8
    v_mov_b32_dpp v87, v75 row_shr:12 row_mask:0xf bank_mask:0x8
    v_perm_b32 v76, v112, v108, s24
    v_perm_b32 v77, v120, v116, s24
    v_perm_b32 v78, v128, v124, s24
    v_perm_b32 v79, v136, v132, s24
    s_nop 1
    v_mfma_f32_16x16x32_bf16 v[8:11], v[76:79], v[36:39], v[8:11]
    v_perm_b32 v4, v114, v110, s24
    v_perm_b32 v5, v122, v118, s24
    v_perm_b32 v6, v130, v126, s24
    v_perm_b32 v7, v138, v134, s24
    s_nop 1
    v_mfma_f32_16x16x32_bf16 v[32:35], v[4:7], v[36:39], v[32:35]
    v_perm_b32 v76, v112, v108, s25
    v_perm_b32 v77, v120, v116, s25
    v_perm_b32 v78, v128, v124, s25
    v_perm_b32 v79, v136, v132, s25
    s_nop 1
    v_mfma_f32_16x16x32_bf16 v[8:11], v[76:79], v[40:43], v[8:11]
    v_perm_b32 v4, v114, v110, s25
    v_perm_b32 v5, v122, v118, s25
    v_perm_b32 v6, v130, v126, s25
    v_perm_b32 v7, v138, v134, s25
    s_nop 1
    v_mfma_f32_16x16x32_bf16 v[32:35], v[4:7], v[40:43], v[32:35]
    v_perm_b32 v76, v113, v109, s24
    v_perm_b32 v77, v121, v117, s24
    v_perm_b32 v78, v129, v125, s24
    v_perm_b32 v79, v137, v133, s24
    s_nop 1
    v_mfma_f32_16x16x32_bf16 v[8:11], v[76:79], v[80:83], v[8:11]
    v_perm_b32 v4, v115, v111, s24
    v_perm_b32 v5, v123, v119, s24
    v_perm_b32 v6, v131, v127, s24
    v_perm_b32 v7, v139, v135, s24
    s_nop 1
    v_mfma_f32_16x16x32_bf16 v[32:35], v[4:7], v[80:83], v[32:35]
    v_perm_b32 v76, v113, v109, s25
    v_perm_b32 v77, v121, v117, s25
    v_perm_b32 v78, v129, v125, s25
    v_perm_b32 v79, v137, v133, s25
    s_nop 1
    v_mfma_f32_16x16x32_bf16 v[8:11], v[76:79], v[84:87], v[8:11]
    v_perm_b32 v4, v115, v111, s25
    v_perm_b32 v5, v123, v119, s25
    v_perm_b32 v6, v131, v127, s25
    v_perm_b32 v7, v139, v135, s25
    s_nop 1
    v_mfma_f32_16x16x32_bf16 v[32:35], v[4:7], v[84:87], v[32:35]
    v_and_b32 v1, 3, v0
    v_lshlrev_b32 v1, 3, v1
    v_mov_b32 v74, 0
    v_mov_b32 v62, 1
    s_lshl_b32 s19, s21, 5
    v_add_u32 v73, s19, v1
    s_mov_b32 s7, 10666666
L_sm_3:
    ds_read_b32 v75, v74 offset:8
    ds_read_b32 v64, v1 offset:256
    ds_read_b32 v65, v1 offset:288
    ds_read_b32 v66, v1 offset:320
    ds_read_b32 v67, v1 offset:352
    ds_read_b32 v68, v1 offset:384
    ds_read_b32 v69, v1 offset:416
    ds_read_b32 v70, v1 offset:448
    ds_read_b32 v71, v1 offset:480
    ds_read_b32 v72, v73 offset:256
    s_waitcnt lgkmcnt(0)
    v_cmp_gt_u32 vcc, 9, v75
    s_cbranch_vccz L_smd_4
    s_sleep 1
    s_sub_u32 s7, s7, 1
    s_cbranch_scc0 L_sm_3
L_smd_4:
    s_mov_b64 exec, 1
    ds_add_rtn_u32 v75, v74, v62 offset:68
    s_mov_b64 exec, -1
    v_max3_f32 v64, v64, v65, v66
    v_max3_f32 v67, v67, v68, v69
    v_max3_f32 v64, v64, v70, v71
    v_max_f32 v64, v64, v67
    v_sub_f32 v64, v72, v64
    v_exp_f32 v64, v64
    s_lshl_b32 s19, s21, 11
    v_add_u32 v1, s19, v2
    s_and_b32 s19, s21, 4
    v_mov_b32 v63, s19
    v_pk_mul_f32 v[8:9], v[8:9], v[64:65] op_sel_hi:[1,0]
    v_pk_mul_f32 v[10:11], v[10:11], v[64:65] op_sel_hi:[1,0]
    v_pk_mul_f32 v[32:33], v[32:33], v[64:65] op_sel_hi:[1,0]
    v_pk_mul_f32 v[34:35], v[34:35], v[64:65] op_sel_hi:[1,0]
    v_pk_mul_f32 v[46:47], v[46:47], v[64:65] op_sel_hi:[1,0]
    v_pk_mul_f32 v[48:49], v[48:49], v[64:65] op_sel_hi:[1,0]
    v_pk_mul_f32 v[50:51], v[50:51], v[64:65] op_sel_hi:[1,0]
    v_pk_mul_f32 v[52:53], v[52:53], v[64:65] op_sel_hi:[1,0]
    v_pk_mul_f32 v[54:55], v[54:55], v[64:65] op_sel_hi:[1,0]
    v_pk_mul_f32 v[56:57], v[56:57], v[64:65] op_sel_hi:[1,0]
    v_pk_mul_f32 v[58:59], v[58:59], v[64:65] op_sel_hi:[1,0]
    v_pk_mul_f32 v[60:61], v[60:61], v[64:65] op_sel_hi:[1,0]
    v_cvt_pk_bf16_f32 v76, v46, v47
    v_cvt_pk_bf16_f32 v77, v48, v49
    v_cvt_pk_bf16_f32 v78, v50, v51
    v_cvt_pk_bf16_f32 v79, v52, v53
    v_cvt_pk_bf16_f32 v4, v54, v55
    v_cvt_pk_bf16_f32 v5, v56, v57
    v_cvt_pk_bf16_f32 v6, v58, v59
    v_cvt_pk_bf16_f32 v7, v60, v61
    v_mov_b32 v44, 0
    v_mov_b32 v45, 0
    v_mov_b32 v46, 0
    v_mov_b32 v47, 0
    v_mov_b32 v48, 0
    v_mov_b32 v49, 0
    v_mov_b32 v50, 0
    v_mov_b32 v51, 0
    v_mov_b32 v52, 0
    v_mov_b32 v53, 0
    v_mov_b32 v54, 0
    v_mov_b32 v55, 0
    v_mov_b32 v56, 0
    v_mov_b32 v57, 0
    v_mov_b32 v58, 0
    v_mov_b32 v59, 0
    v_mov_b32_dpp v36, v76 quad_perm:[0,1,2,3] row_mask:0xf bank_mask:0x1
    v_mov_b32_dpp v37, v77 quad_perm:[0,1,2,3] row_mask:0xf bank_mask:0x1
    v_mov_b32_dpp v38, v78 quad_perm:[0,1,2,3] row_mask:0xf bank_mask:0x1
    v_mov_b32_dpp v39, v79 quad_perm:[0,1,2,3] row_mask:0xf bank_mask:0x1
    v_mov_b32_dpp v40, v76 row_shr:4 row_mask:0xf bank_mask:0x2
    v_mov_b32_dpp v41, v77 row_shr:4 row_mask:0xf bank_mask:0x2
    v_mov_b32_dpp v42, v78 row_shr:4 row_mask:0xf bank_mask:0x2
    v_mov_b32_dpp v43, v79 row_shr:4 row_mask:0xf bank_mask:0x2
    v_mov_b32_dpp v80, v76 row_shr:8 row_mask:0xf bank_mask:0x4
    v_mov_b32_dpp v81, v77 row_shr:8 row_mask:0xf bank_mask:0x4
    v_mov_b32_dpp v82, v78 row_shr:8 row_mask:0xf bank_mask:0x4
    v_mov_b32_dpp v83, v79 row_shr:8 row_mask:0xf bank_mask:0x4
    v_mov_b32_dpp v84, v76 row_shr:12 row_mask:0xf bank_mask:0x8
    v_mov_b32_dpp v85, v77 row_shr:12 row_mask:0xf bank_mask:0x8
    v_mov_b32_dpp v86, v78 row_shr:12 row_mask:0xf bank_mask:0x8
    v_mov_b32_dpp v87, v79 row_shr:12 row_mask:0xf bank_mask:0x8
    v_mov_b32_dpp v44, v4 quad_perm:[0,1,2,3] row_mask:0xf bank_mask:0x1
    v_mov_b32_dpp v45, v5 quad_perm:[0,1,2,3] row_mask:0xf bank_mask:0x1
    v_mov_b32_dpp v46, v6 quad_perm:[0,1,2,3] row_mask:0xf bank_mask:0x1
    v_mov_b32_dpp v47, v7 quad_perm:[0,1,2,3] row_mask:0xf bank_mask:0x1
    v_mov_b32_dpp v48, v4 row_shr:4 row_mask:0xf bank_mask:0x2
    v_mov_b32_dpp v49, v5 row_shr:4 row_mask:0xf bank_mask:0x2
    v_mov_b32_dpp v50, v6 row_shr:4 row_mask:0xf bank_mask:0x2
    v_mov_b32_dpp v51, v7 row_shr:4 row_mask:0xf bank_mask:0x2
    v_mov_b32_dpp v52, v4 row_shr:8 row_mask:0xf bank_mask:0x4
    v_mov_b32_dpp v53, v5 row_shr:8 row_mask:0xf bank_mask:0x4
    v_mov_b32_dpp v54, v6 row_shr:8 row_mask:0xf bank_mask:0x4
    v_mov_b32_dpp v55, v7 row_shr:8 row_mask:0xf bank_mask:0x4
    v_mov_b32_dpp v56, v4 row_shr:12 row_mask:0xf bank_mask:0x8
    v_mov_b32_dpp v57, v5 row_shr:12 row_mask:0xf bank_mask:0x8
    v_mov_b32_dpp v58, v6 row_shr:12 row_mask:0xf bank_mask:0x8
    v_mov_b32_dpp v59, v7 row_shr:12 row_mask:0xf bank_mask:0x8
    s_waitcnt lgkmcnt(0)
    v_readfirstlane_b32 s23, v75
    s_waitcnt vmcnt(4)
    v_perm_b32 v104, v144, v140, s24
    v_perm_b32 v120, v146, v142, s24
    v_perm_b32 v108, v144, v140, s25
    v_perm_b32 v124, v146, v142, s25
    v_perm_b32 v112, v145, v141, s24
    v_perm_b32 v128, v147, v143, s24
    v_perm_b32 v116, v145, v141, s25
    v_perm_b32 v132, v147, v143, s25
    s_waitcnt vmcnt(3)
    s_add_u32 s20, s16, 131072
    buffer_load_dwordx4 v[164:167], v2, s[12:15], s20 offen offset:2048 nt
    s_waitcnt vmcnt(3)
    buffer_load_dwordx4 v[12:15], v2, s[12:15], s20 offen offset:3072 nt
    v_perm_b32 v105, v152, v148, s24
    v_perm_b32 v121, v154, v150, s24
    v_perm_b32 v109, v152, v148, s25
    v_perm_b32 v125, v154, v150, s25
    v_perm_b32 v113, v153, v149, s24
    v_perm_b32 v129, v155, v151, s24
    v_perm_b32 v117, v153, v149, s25
    v_perm_b32 v133, v155, v151, s25
    s_waitcnt vmcnt(3)
    s_add_u32 s20, s16, 163840
    buffer_load_dwordx4 v[16:19], v2, s[12:15], s20 offen offset:0 nt
    s_waitcnt vmcnt(3)
    v_perm_b32 v106, v160, v156, s24
    v_perm_b32 v122, v162, v158, s24
    v_perm_b32 v110, v160, v156, s25
    v_perm_b32 v126, v162, v158, s25
    v_perm_b32 v114, v161, v157, s24
    v_perm_b32 v130, v163, v159, s24
    v_perm_b32 v118, v161, v157, s25
    v_perm_b32 v134, v163, v159, s25
    s_waitcnt vmcnt(2)
    buffer_load_dwordx4 v[20:23], v2, s[12:15], s20 offen offset:1024 nt
    buffer_load_dwordx4 v[24:27], v2, s[12:15], s20 offen offset:2048 nt
    buffer_load_dwordx4 v[28:31], v2, s[12:15], s20 offen offset:3072 nt
    s_add_u32 s20, s16, 196608
    buffer_load_dwordx4 v[88:91], v2, s[12:15], s20 offen offset:0 nt
    buffer_load_dwordx4 v[92:95], v2, s[12:15], s20 offen offset:1024 nt
    buffer_load_dwordx4 v[96:99], v2, s[12:15], s20 offen offset:2048 nt
    buffer_load_dwordx4 v[100:103], v2, s[12:15], s20 offen offset:3072 nt
    s_mov_b64 exec, 1
    ds_add_u32 v2, v62 offset:24
    s_mov_b64 exec, -1
    s_waitcnt vmcnt(8)
    v_perm_b32 v107, v12, v164, s24
    v_perm_b32 v123, v14, v166, s24
    v_perm_b32 v111, v12, v164, s25
    v_perm_b32 v127, v14, v166, s25
    v_perm_b32 v115, v13, v165, s24
    v_perm_b32 v131, v15, v167, s24
    v_perm_b32 v119, v13, v165, s25
    v_perm_b32 v135, v15, v167, s25
    v_mfma_f32_16x16x32_bf16 v[8:11], v[104:107], v[36:39], v[8:11]
    v_mfma_f32_16x16x32_bf16 v[32:35], v[120:123], v[36:39], v[32:35]
    v_mfma_f32_16x16x32_bf16 v[8:11], v[108:111], v[40:43], v[8:11]
    v_mfma_f32_16x16x32_bf16 v[32:35], v[124:127], v[40:43], v[32:35]
    v_mfma_f32_16x16x32_bf16 v[8:11], v[112:115], v[80:83], v[8:11]
    v_mfma_f32_16x16x32_bf16 v[32:35], v[128:131], v[80:83], v[32:35]
    v_mfma_f32_16x16x32_bf16 v[8:11], v[116:119], v[84:87], v[8:11]
    v_mfma_f32_16x16x32_bf16 v[32:35], v[132:135], v[84:87], v[32:35]
    s_waitcnt vmcnt(6)
    v_perm_b32 v104, v20, v16, s24
    v_perm_b32 v120, v22, v18, s24
    v_perm_b32 v108, v20, v16, s25
    v_perm_b32 v124, v22, v18, s25
    v_perm_b32 v112, v21, v17, s24
    v_perm_b32 v128, v23, v19, s24
    v_perm_b32 v116, v21, v17, s25
    v_perm_b32 v132, v23, v19, s25
    s_waitcnt vmcnt(4)
    v_perm_b32 v105, v28, v24, s24
    v_perm_b32 v121, v30, v26, s24
    v_perm_b32 v109, v28, v24, s25
    v_perm_b32 v125, v30, v26, s25
    v_perm_b32 v113, v29, v25, s24
    v_perm_b32 v129, v31, v27, s24
    v_perm_b32 v117, v29, v25, s25
    v_perm_b32 v133, v31, v27, s25
    s_waitcnt vmcnt(2)
    v_perm_b32 v106, v92, v88, s24
    v_perm_b32 v122, v94, v90, s24
    v_perm_b32 v110, v92, v88, s25
    v_perm_b32 v126, v94, v90, s25
    v_perm_b32 v114, v93, v89, s24
    v_perm_b32 v130, v95, v91, s24
    v_perm_b32 v118, v93, v89, s25
    v_perm_b32 v134, v95, v91, s25
    s_waitcnt vmcnt(0)
    v_perm_b32 v107, v100, v96, s24
    v_perm_b32 v123, v102, v98, s24
    v_perm_b32 v111, v100, v96, s25
    v_perm_b32 v127, v102, v98, s25
    v_perm_b32 v115, v101, v97, s24
    v_perm_b32 v131, v103, v99, s24
    v_perm_b32 v119, v101, v97, s25
    v_perm_b32 v135, v103, v99, s25
    v_mfma_f32_16x16x32_bf16 v[8:11], v[104:107], v[44:47], v[8:11]
    v_mfma_f32_16x16x32_bf16 v[32:35], v[120:123], v[44:47], v[32:35]
    v_mfma_f32_16x16x32_bf16 v[8:11], v[108:111], v[48:51], v[8:11]
    v_mfma_f32_16x16x32_bf16 v[32:35], v[124:127], v[48:51], v[32:35]
    v_mfma_f32_16x16x32_bf16 v[8:11], v[112:115], v[52:55], v[8:11]
    v_mfma_f32_16x16x32_bf16 v[32:35], v[128:131], v[52:55], v[32:35]
    v_mfma_f32_16x16x32_bf16 v[8:11], v[116:119], v[56:59], v[8:11]
    v_mfma_f32_16x16x32_bf16 v[32:35], v[132:135], v[56:59], v[32:35]
    s_nop 6
    ds_write_b128 v1, v[8:11] offset:16384
    ds_write_b128 v1, v[32:35] offset:17408
    s_mov_b64 exec, 1
    ds_add_u32 v63, v62 offset:32
    s_mov_b64 exec, -1
    s_cmp_lg_u32 s23, 0
    s_cbranch_scc1 L_done
    s_setprio 3
    s_lshl_b32 s20, s4, 15
    s_lshr_b32 s19, s5, 4
    s_lshl_b32 s19, s19, 10
    s_add_u32 s20, s20, s19
    s_and_b32 s19, s5, 15
    s_lshl_b32 s19, s19, 4
    s_add_u32 s20, s20, s19
    s_add_u32 s20, s20, 1048576
    v_and_b32 v36, 3, v0
    v_lshlrev_b32 v36, 13, v36
    v_bfe_u32 v37, v0, 2, 2
    v_lshl_add_u32 v36, v37, 11, v36
    v_lshrrev_b32 v37, 4, v0
    v_lshl_add_u32 v36, v37, 8, v36
    v_add_u32 v36, s20, v36
    v_add_u32 v37, 262144, v36
    v_mov_b32 v38, 0
    v_mov_b32 v39, 1
    ds_read_b32 v29, v38 offset:64
    s_waitcnt lgkmcnt(0)
    v_readfirstlane_b32 s26, v29
    s_mov_b32 s7, 10666666
L_so_5:
    ds_read_b32 v28, v38 offset:32
    ds_read_b128 v[40:43], v2 offset:16384
    ds_read_b128 v[44:47], v2 offset:17408
    ds_read_b128 v[48:51], v2 offset:18432
    ds_read_b128 v[52:55], v2 offset:19456
    ds_read_b128 v[56:59], v2 offset:20480
    ds_read_b128 v[60:63], v2 offset:21504
    ds_read_b128 v[64:67], v2 offset:22528
    ds_read_b128 v[68:71], v2 offset:23552
    s_waitcnt lgkmcnt(0)
    v_cmp_gt_u32 vcc, 4, v28
    s_cbranch_vccz L_sod_6
    s_sleep 1
    s_sub_u32 s7, s7, 1
    s_cbranch_scc0 L_so_5
L_sod_6:
    v_pk_add_f32 v[40:41], v[40:41], v[48:49]
    v_pk_add_f32 v[42:43], v[42:43], v[50:51]
    v_pk_add_f32 v[44:45], v[44:45], v[52:53]
    v_pk_add_f32 v[46:47], v[46:47], v[54:55]
    v_pk_add_f32 v[56:57], v[56:57], v[64:65]
    v_pk_add_f32 v[58:59], v[58:59], v[66:67]
    v_pk_add_f32 v[60:61], v[60:61], v[68:69]
    v_pk_add_f32 v[62:63], v[62:63], v[70:71]
    v_pk_add_f32 v[12:13], v[40:41], v[56:57]
    v_pk_add_f32 v[14:15], v[42:43], v[58:59]
    v_pk_add_f32 v[16:17], v[44:45], v[60:61]
    v_pk_add_f32 v[18:19], v[46:47], v[62:63]
    s_mov_b32 s7, 16000000
L_so_7:
    ds_read_b32 v28, v38 offset:36
    ds_read_b128 v[40:43], v2 offset:24576
    ds_read_b128 v[44:47], v2 offset:25600
    ds_read_b128 v[48:51], v2 offset:26624
    ds_read_b128 v[52:55], v2 offset:27648
    ds_read_b128 v[56:59], v2 offset:28672
    ds_read_b128 v[60:63], v2 offset:29696
    ds_read_b128 v[64:67], v2 offset:30720
    ds_read_b128 v[68:71], v2 offset:31744
    s_waitcnt lgkmcnt(0)
    v_cmp_gt_u32 vcc, 4, v28
    s_cbranch_vccz L_sod_8
    s_sub_u32 s7, s7, 1
    s_cbranch_scc0 L_so_7
L_sod_8:
    v_pk_add_f32 v[40:41], v[40:41], v[48:49]
    v_pk_add_f32 v[42:43], v[42:43], v[50:51]
    v_pk_add_f32 v[44:45], v[44:45], v[52:53]
    v_pk_add_f32 v[46:47], v[46:47], v[54:55]
    v_pk_add_f32 v[56:57], v[56:57], v[64:65]
    v_pk_add_f32 v[58:59], v[58:59], v[66:67]
    v_pk_add_f32 v[60:61], v[60:61], v[68:69]
    v_pk_add_f32 v[62:63], v[62:63], v[70:71]
    v_pk_add_f32 v[40:41], v[40:41], v[56:57]
    v_pk_add_f32 v[42:43], v[42:43], v[58:59]
    v_pk_add_f32 v[44:45], v[44:45], v[60:61]
    v_pk_add_f32 v[46:47], v[46:47], v[62:63]
    v_pk_add_f32 v[12:13], v[12:13], v[40:41]
    v_pk_add_f32 v[14:15], v[14:15], v[42:43]
    v_pk_add_f32 v[16:17], v[16:17], v[44:45]
    v_pk_add_f32 v[18:19], v[18:19], v[46:47]
    v_cvt_pk_bf16_f32 v12, v12, v13
    v_cvt_pk_bf16_f32 v13, v14, v15
    v_cvt_pk_bf16_f32 v14, v16, v17
    v_cvt_pk_bf16_f32 v15, v18, v19
    global_store_dwordx4 v37, v[12:15], s[60:61]
    s_cmp_eq_u32 s26, 0
    s_cbranch_scc1 L_ng2
    global_store_dwordx4 v36, v[12:15], s[60:61] sc1
L_ng2:
    ds_write_b32 v38, v39 offset:12
    s_endpgm
L_nh:
    v_lshlrev_b32 v1, 17, v12
    v_lshl_add_u32 v1, v13, 4, v1
    s_lshl_b32 s20, s3, 20
    s_lshl_b32 s21, s4, 10
    s_add_u32 s20, s20, s21
    s_mov_b32 s26, s65
    s_lshl_b32 s21, s26, 7
    s_add_u32 s20, s20, s21
    s_lshl_b32 s21, s3, 8
    v_lshl_add_u32 v14, v0, 2, s21
    s_waitcnt lgkmcnt(0)
    s_mov_b32 s8, s42
    s_mov_b32 s9, s43
    s_mov_b32 s10, 4194304
    s_mov_b32 s11, 0x20000
    global_load_dwordx4 v[8:11], v2, s[36:37]
    global_load_dword v15, v14, s[36:37]
    buffer_load_dwordx4 v[40:43], v1, s[8:11], s20 offen
    s_add_u32 s20, s20, 8192
    buffer_load_dwordx4 v[44:47], v1, s[8:11], s20 offen
    s_add_u32 s20, s20, 8192
    buffer_load_dwordx4 v[48:51], v1, s[8:11], s20 offen
    s_add_u32 s20, s20, 8192
    buffer_load_dwordx4 v[52:55], v1, s[8:11], s20 offen
    s_add_u32 s20, s20, 8192
    buffer_load_dwordx4 v[56:59], v1, s[8:11], s20 offen
    s_add_u32 s20, s20, 8192
    buffer_load_dwordx4 v[60:63], v1, s[8:11], s20 offen
    s_add_u32 s20, s20, 8192
    buffer_load_dwordx4 v[64:67], v1, s[8:11], s20 offen
    s_add_u32 s20, s20, 8192
    buffer_load_dwordx4 v[68:71], v1, s[8:11], s20 offen
    s_add_u32 s20, s20, 8192
    buffer_load_dwordx4 v[72:75], v1, s[8:11], s20 offen
    s_add_u32 s20, s20, 8192
    buffer_load_dwordx4 v[76:79], v1, s[8:11], s20 offen
    s_add_u32 s20, s20, 8192
    buffer_load_dwordx4 v[80:83], v1, s[8:11], s20 offen
    s_add_u32 s20, s20, 8192
    buffer_load_dwordx4 v[84:87], v1, s[8:11], s20 offen
    s_add_u32 s20, s20, 8192
    buffer_load_dwordx4 v[88:91], v1, s[8:11], s20 offen
    s_add_u32 s20, s20, 8192
    buffer_load_dwordx4 v[92:95], v1, s[8:11], s20 offen
    s_add_u32 s20, s20, 8192
    buffer_load_dwordx4 v[96:99], v1, s[8:11], s20 offen
    s_add_u32 s20, s20, 8192
    buffer_load_dwordx4 v[100:103], v1, s[8:11], s20 offen
    s_load_dword s6, s[60:61], 0
    s_barrier
    s_lshl_b32 s26, s26, 8
    s_lshl_b32 s21, s4, 11
    s_add_u32 s26, s26, s21
    s_add_u32 s26, s26, 32768
    s_waitcnt vmcnt(16)
    v_lshlrev_b32 v32, 16, v8
    v_and_b32 v33, 0xffff0000, v8
    v_lshlrev_b32 v34, 16, v9
    v_and_b32 v35, 0xffff0000, v9
    v_lshlrev_b32 v36, 16, v10
    v_and_b32 v37, 0xffff0000, v10
    v_lshlrev_b32 v38, 16, v11
    v_and_b32 v39, 0xffff0000, v11
    v_add_f32 v4, v32, v33
    v_add_f32 v4, v4, v34
    v_add_f32 v4, v4, v35
    v_add_f32 v4, v4, v36
    v_add_f32 v4, v4, v37
    v_add_f32 v4, v4, v38
    v_add_f32 v4, v4, v39
    s_nop 1
    v_add_f32_dpp v4, v4, v4 row_ror:8 row_mask:0xf bank_mask:0xf
    s_nop 1
    v_add_f32_dpp v4, v4, v4 row_ror:4 row_mask:0xf bank_mask:0xf
    s_nop 1
    v_add_f32_dpp v4, v4, v4 row_ror:2 row_mask:0xf bank_mask:0xf
    s_nop 1
    v_add_f32_dpp v4, v4, v4 row_ror:1 row_mask:0xf bank_mask:0xf
    v_mov_b32 v5, v4
    s_nop 1
    v_permlane16_swap_b32 v4, v5
    v_add_f32 v4, v4, v5
    v_mov_b32 v5, v4
    s_nop 1
    v_permlane32_swap_b32 v4, v5
    v_add_f32 v4, v4, v5
    v_mul_f32 v4, 0x3b000000, v4
    v_sub_f32 v32, v32, v4
    v_sub_f32 v33, v33, v4
    v_sub_f32 v34, v34, v4
    v_sub_f32 v35, v35, v4
    v_sub_f32 v36, v36, v4
    v_sub_f32 v37, v37, v4
    v_sub_f32 v38, v38, v4
    v_sub_f32 v39, v39, v4
    v_mul_f32 v6, v32, v32
    v_fmac_f32 v6, v33, v33
    v_fmac_f32 v6, v34, v34
    v_fmac_f32 v6, v35, v35
    v_fmac_f32 v6, v36, v36
    v_fmac_f32 v6, v37, v37
    v_fmac_f32 v6, v38, v38
    v_fmac_f32 v6, v39, v39
    s_nop 1
    v_add_f32_dpp v6, v6, v6 row_ror:8 row_mask:0xf bank_mask:0xf
    s_nop 1
    v_add_f32_dpp v6, v6, v6 row_ror:4 row_mask:0xf bank_mask:0xf
    s_nop 1
    v_add_f32_dpp v6, v6, v6 row_ror:2 row_mask:0xf bank_mask:0xf
    s_nop 1
    v_add_f32_dpp v6, v6, v6 row_ror:1 row_mask:0xf bank_mask:0xf
    v_mov_b32 v5, v6
    s_nop 1
    v_permlane16_swap_b32 v6, v5
    v_add_f32 v6, v6, v5
    v_mov_b32 v5, v6
    s_nop 1
    v_permlane32_swap_b32 v6, v5
    v_add_f32 v6, v6, v5
    v_mul_f32 v5, 0x3b000000, v6
    v_cvt_pk_bf16_f32 v5, v4, v5
    v_lshlrev_b32 v4, 16, v5
    v_and_b32 v5, 0xffff0000, v5
    v_add_f32 v5, 0x3727c5ac, v5
    v_cvt_pk_bf16_f32 v5, v5, v5
    v_lshlrev_b32 v5, 16, v5
    v_sqrt_f32 v5, v5
    s_nop 0
    v_cvt_pk_bf16_f32 v5, v5, v5
    v_lshlrev_b32 v5, 16, v5
    v_rcp_f32 v5, v5
    v_lshlrev_b32 v8, 16, v15
    v_and_b32 v9, 0xffff0000, v15
    v_sub_f32 v8, v8, v4
    v_sub_f32 v9, v9, v4
    v_cvt_pk_bf16_f32 v9, v8, v9
    v_lshlrev_b32 v8, 16, v9
    v_and_b32 v9, 0xffff0000, v9
    v_mul_f32 v8, v8, v5
    v_mul_f32 v9, v9, v5
    v_cvt_pk_bf16_f32 v9, v8, v9
    v_lshlrev_b32 v8, 16, v9
    v_and_b32 v9, 0xffff0000, v9
    v_lshlrev_b32 v15, 2, v14
    v_add_u32 v15, 98304, v15
    v_add_u32 v10, 4096, v15
    v_add_u32 v11, 8192, v15
    v_add_u32 v7, 12288, v15
    s_waitcnt lgkmcnt(0)
    s_mul_i32 s6, s6, 0x9E3779B1
    s_add_u32 s6, s6, 0x7F4A7C15
    s_waitcnt vmcnt(0)
    v_perm_b32 v104, v44, v40, s24
    v_perm_b32 v105, v44, v40, s25
    v_perm_b32 v106, v45, v41, s24
    v_perm_b32 v107, v45, v41, s25
    v_perm_b32 v108, v46, v42, s24
    v_perm_b32 v109, v46, v42, s25
    v_perm_b32 v110, v47, v43, s24
    v_perm_b32 v111, v47, v43, s25
    v_perm_b32 v112, v52, v48, s24
    v_perm_b32 v113, v52, v48, s25
    v_perm_b32 v114, v53, v49, s24
    v_perm_b32 v115, v53, v49, s25
    v_perm_b32 v116, v54, v50, s24
    v_perm_b32 v117, v54, v50, s25
    v_perm_b32 v118, v55, v51, s24
    v_perm_b32 v119, v55, v51, s25
    v_perm_b32 v120, v60, v56, s24
    v_perm_b32 v121, v60, v56, s25
    v_perm_b32 v122, v61, v57, s24
    v_perm_b32 v123, v61, v57, s25
    v_perm_b32 v124, v62, v58, s24
    v_perm_b32 v125, v62, v58, s25
    v_perm_b32 v126, v63, v59, s24
    v_perm_b32 v127, v63, v59, s25
    v_perm_b32 v128, v68, v64, s24
    v_perm_b32 v129, v68, v64, s25
    v_perm_b32 v130, v69, v65, s24
    v_perm_b32 v131, v69, v65, s25
    v_perm_b32 v132, v70, v66, s24
    v_perm_b32 v133, v70, v66, s25
    v_perm_b32 v134, v71, v67, s24
    v_perm_b32 v135, v71, v67, s25
    v_perm_b32 v136, v76, v72, s24
    v_perm_b32 v137, v76, v72, s25
    v_perm_b32 v138, v77, v73, s24
    v_perm_b32 v139, v77, v73, s25
    v_perm_b32 v140, v78, v74, s24
    v_perm_b32 v141, v78, v74, s25
    v_perm_b32 v142, v79, v75, s24
    v_perm_b32 v143, v79, v75, s25
    v_perm_b32 v144, v84, v80, s24
    v_perm_b32 v145, v84, v80, s25
    v_perm_b32 v146, v85, v81, s24
    v_perm_b32 v147, v85, v81, s25
    v_perm_b32 v148, v86, v82, s24
    v_perm_b32 v149, v86, v82, s25
    v_perm_b32 v150, v87, v83, s24
    v_perm_b32 v151, v87, v83, s25
    v_perm_b32 v152, v92, v88, s24
    v_perm_b32 v153, v92, v88, s25
    v_perm_b32 v154, v93, v89, s24
    v_perm_b32 v155, v93, v89, s25
    v_perm_b32 v156, v94, v90, s24
    v_perm_b32 v157, v94, v90, s25
    v_perm_b32 v158, v95, v91, s24
    v_perm_b32 v159, v95, v91, s25
    v_perm_b32 v160, v100, v96, s24
    v_perm_b32 v161, v100, v96, s25
    v_perm_b32 v162, v101, v97, s24
    v_perm_b32 v163, v101, v97, s25
    v_perm_b32 v164, v102, v98, s24
    v_perm_b32 v165, v102, v98, s25
    v_perm_b32 v166, v103, v99, s24
    v_perm_b32 v167, v103, v99, s25
    v_mov_b32 v4, 0
    s_mov_b32 s7, 8000000
L_sh_9:
    ds_read_b32 v5, v4 offset:72
    s_waitcnt lgkmcnt(0)
    v_cmp_gt_u32 vcc, 1, v5
    s_cbranch_vccz L_shd_10
    s_sleep 2
    s_sub_u32 s7, s7, 1
    s_cbranch_scc0 L_sh_9
L_shd_10:
    s_mov_b32 s7, 4000000
L_ph_11:
    global_load_dwordx4 v[16:19], v15, s[60:61] sc1
    global_load_dwordx4 v[20:23], v10, s[60:61] sc1
    global_load_dwordx4 v[24:27], v11, s[60:61] sc1
    global_load_dwordx4 v[28:31], v7, s[60:61] sc1
    s_waitcnt vmcnt(0)
    v_xor_b32 v4, s6, v17
    v_xor_b32 v5, s6, v19
    v_or_b32 v4, v4, v5
    v_xor_b32 v5, s6, v21
    v_or_b32 v4, v4, v5
    v_xor_b32 v5, s6, v23
    v_or_b32 v4, v4, v5
    v_xor_b32 v5, s6, v25
    v_or_b32 v4, v4, v5
    v_xor_b32 v5, s6, v27
    v_or_b32 v4, v4, v5
    v_xor_b32 v5, s6, v29
    v_or_b32 v4, v4, v5
    v_xor_b32 v5, s6, v31
    v_or_b32 v4, v4, v5
    v_cmp_ne_u32 vcc, 0, v4
    s_cbranch_vccz L_phd_12
    s_mov_b64 exec, vcc
    s_sleep 4
    s_sub_u32 s7, s7, 1
    s_cbranch_scc0 L_ph_11
L_phd_12:
    s_mov_b64 exec, -1
    v_add_f32 v16, v16, v20
    v_add_f32 v17, v18, v22
    v_add_f32 v18, v24, v28
    v_add_f32 v19, v26, v30
    v_cvt_pk_bf16_f32 v17, v16, v17
    v_lshlrev_b32 v16, 16, v17
    v_and_b32 v17, 0xffff0000, v17
    v_cvt_pk_bf16_f32 v19, v18, v19
    v_lshlrev_b32 v18, 16, v19
    v_and_b32 v19, 0xffff0000, v19
    v_add_f32 v18, 1.0, v18
    v_add_f32 v19, 1.0, v19
    v_cvt_pk_bf16_f32 v19, v18, v19
    v_lshlrev_b32 v18, 16, v19
    v_and_b32 v19, 0xffff0000, v19
    v_pk_mul_f32 v[24:25], v[8:9], v[18:19]
    v_cvt_pk_bf16_f32 v25, v24, v25
    v_lshlrev_b32 v24, 16, v25
    v_and_b32 v25, 0xffff0000, v25
    v_pk_add_f32 v[24:25], v[24:25], v[16:17]
L_gx:
    v_cvt_pk_bf16_f32 v24, v24, v25
    ds_write_b32 v14, v24 offset:3072
    s_lshl_b32 s21, s3, 8
    v_lshl_add_u32 v15, v12, 5, s21
    ds_read_b128 v[24:27], v15 offset:3072
    ds_read_b128 v[28:31], v15 offset:3088
    s_waitcnt lgkmcnt(0)
    v_dot2_f32_bf16 v32, v104, v24, 0
    v_dot2_f32_bf16 v33, v105, v24, 0
    v_dot2_f32_bf16 v34, v106, v24, 0
    v_dot2_f32_bf16 v35, v107, v24, 0
    v_dot2_f32_bf16 v36, v108, v24, 0
    v_dot2_f32_bf16 v37, v109, v24, 0
    v_dot2_f32_bf16 v38, v110, v24, 0
    v_dot2_f32_bf16 v39, v111, v24, 0
    v_dot2_f32_bf16 v32, v112, v25, v32
    v_dot2_f32_bf16 v33, v113, v25, v33
    v_dot2_f32_bf16 v34, v114, v25, v34
    v_dot2_f32_bf16 v35, v115, v25, v35
    v_dot2_f32_bf16 v36, v116, v25, v36
    v_dot2_f32_bf16 v37, v117, v25, v37
    v_dot2_f32_bf16 v38, v118, v25, v38
    v_dot2_f32_bf16 v39, v119, v25, v39
    v_dot2_f32_bf16 v32, v120, v26, v32
    v_dot2_f32_bf16 v33, v121, v26, v33
    v_dot2_f32_bf16 v34, v122, v26, v34
    v_dot2_f32_bf16 v35, v123, v26, v35
    v_dot2_f32_bf16 v36, v124, v26, v36
    v_dot2_f32_bf16 v37, v125, v26, v37
    v_dot2_f32_bf16 v38, v126, v26, v38
    v_dot2_f32_bf16 v39, v127, v26, v39
    v_dot2_f32_bf16 v32, v128, v27, v32
    v_dot2_f32_bf16 v33, v129, v27, v33
    v_dot2_f32_bf16 v34, v130, v27, v34
    v_dot2_f32_bf16 v35, v131, v27, v35
    v_dot2_f32_bf16 v36, v132, v27, v36
    v_dot2_f32_bf16 v37, v133, v27, v37
    v_dot2_f32_bf16 v38, v134, v27, v38
    v_dot2_f32_bf16 v39, v135, v27, v39
    v_dot2_f32_bf16 v32, v136, v28, v32
    v_dot2_f32_bf16 v33, v137, v28, v33
    v_dot2_f32_bf16 v34, v138, v28, v34
    v_dot2_f32_bf16 v35, v139, v28, v35
    v_dot2_f32_bf16 v36, v140, v28, v36
    v_dot2_f32_bf16 v37, v141, v28, v37
    v_dot2_f32_bf16 v38, v142, v28, v38
    v_dot2_f32_bf16 v39, v143, v28, v39
    v_dot2_f32_bf16 v32, v144, v29, v32
    v_dot2_f32_bf16 v33, v145, v29, v33
    v_dot2_f32_bf16 v34, v146, v29, v34
    v_dot2_f32_bf16 v35, v147, v29, v35
    v_dot2_f32_bf16 v36, v148, v29, v36
    v_dot2_f32_bf16 v37, v149, v29, v37
    v_dot2_f32_bf16 v38, v150, v29, v38
    v_dot2_f32_bf16 v39, v151, v29, v39
    v_dot2_f32_bf16 v32, v152, v30, v32
    v_dot2_f32_bf16 v33, v153, v30, v33
    v_dot2_f32_bf16 v34, v154, v30, v34
    v_dot2_f32_bf16 v35, v155, v30, v35
    v_dot2_f32_bf16 v36, v156, v30, v36
    v_dot2_f32_bf16 v37, v157, v30, v37
    v_dot2_f32_bf16 v38, v158, v30, v38
    v_dot2_f32_bf16 v39, v159, v30, v39
    v_dot2_f32_bf16 v32, v160, v31, v32
    v_dot2_f32_bf16 v33, v161, v31, v33
    v_dot2_f32_bf16 v34, v162, v31, v34
    v_dot2_f32_bf16 v35, v163, v31, v35
    v_dot2_f32_bf16 v36, v164, v31, v36
    v_dot2_f32_bf16 v37, v165, v31, v37
    v_dot2_f32_bf16 v38, v166, v31, v38
    v_dot2_f32_bf16 v39, v167, v31, v39
    s_branch L_gfin
L_role:
    s_cmp_eq_u32 s64, 0
    s_cbranch_scc1 L_qpoll
    s_cmp_eq_u32 s64, 4
    s_cbranch_scc1 L_wb
    s_cmp_lg_u32 s64, 5
    s_cbranch_scc1 L_m
    s_cmp_lg_u32 s3, 0
    s_cbranch_scc1 L_qpoll
    s_lshl_b32 s20, s65, 7
    s_add_u32 s20, s20, 1572864
    s_add_u32 s72, s60, s20
    s_addc_u32 s73, s61, 0
    v_lshlrev_b32 v4, 10, v12
    v_lshl_add_u32 v4, v13, 4, v4
    global_store_dwordx4 v4, v[16:19], s[72:73] sc1
    v_add_u32 v4, 8192, v4
    global_store_dwordx4 v4, v[16:19], s[72:73] sc1
    v_add_u32 v4, 8192, v4
    global_store_dwordx4 v4, v[16:19], s[72:73] sc1
    v_add_u32 v4, 8192, v4
    global_store_dwordx4 v4, v[16:19], s[72:73] sc1
    s_mov_b32 s80, -1
    s_mov_b32 s81, -1
    s_mov_b32 s82, -1
    s_mov_b32 s83, -1
    s_waitcnt vmcnt(0)
    s_memtime s[76:77]
    s_waitcnt lgkmcnt(0)
    s_load_dword s74, s[72:73], 0
    s_waitcnt lgkmcnt(0)
    s_memtime s[78:79]
    s_waitcnt lgkmcnt(0)
    s_sub_u32 s21, s78, s76
    s_min_u32 s80, s80, s21
    s_load_dword s74, s[72:73], 8192
    s_waitcnt lgkmcnt(0)
    s_memtime s[76:77]
    s_waitcnt lgkmcnt(0)
    s_sub_u32 s21, s76, s78
    s_min_u32 s81, s81, s21
    s_load_dword s74, s[72:73], 16384
    s_waitcnt lgkmcnt(0)
    s_memtime s[78:79]
    s_waitcnt lgkmcnt(0)
    s_sub_u32 s21, s78, s76
    s_min_u32 s82, s82, s21
    s_load_dword s74, s[72:73], 24576
    s_waitcnt lgkmcnt(0)
    s_memtime s[76:77]
    s_waitcnt lgkmcnt(0)
    s_sub_u32 s21, s76, s78
    s_min_u32 s83, s83, s21
    s_load_dword s74, s[72:73], 9216
    s_waitcnt lgkmcnt(0)
    s_memtime s[78:79]
    s_waitcnt lgkmcnt(0)
    s_sub_u32 s21, s78, s76
    s_min_u32 s81, s81, s21
    s_load_dword s74, s[72:73], 17408
    s_waitcnt lgkmcnt(0)
    s_memtime s[76:77]
    s_waitcnt lgkmcnt(0)
    s_sub_u32 s21, s76, s78
    s_min_u32 s82, s82, s21
    s_load_dword s74, s[72:73], 25600
    s_waitcnt lgkmcnt(0)
    s_memtime s[78:79]
    s_waitcnt lgkmcnt(0)
    s_sub_u32 s21, s78, s76
    s_min_u32 s83, s83, s21
    s_load_dword s74, s[72:73], 1024
    s_waitcnt lgkmcnt(0)
    s_memtime s[76:77]
    s_waitcnt lgkmcnt(0)
    s_sub_u32 s21, s76, s78
    s_min_u32 s80, s80, s21
    s_load_dword s74, s[72:73], 18432
    s_waitcnt lgkmcnt(0)
    s_memtime s[78:79]
    s_waitcnt lgkmcnt(0)
    s_sub_u32 s21, s78, s76
    s_min_u32 s82, s82, s21
    s_load_dword s74, s[72:73], 26624
    s_waitcnt lgkmcnt(0)
    s_memtime s[76:77]
    s_waitcnt lgkmcnt(0)
    s_sub_u32 s21, s76, s78
    s_min_u32 s83, s83, s21
    s_load_dword s74, s[72:73], 2048
    s_waitcnt lgkmcnt(0)
    s_memtime s[78:79]
    s_waitcnt lgkmcnt(0)
    s_sub_u32 s21, s78, s76
    s_min_u32 s80, s80, s21
    s_load_dword s74, s[72:73], 10240
    s_waitcnt lgkmcnt(0)
    s_memtime s[76:77]
    s_waitcnt lgkmcnt(0)
    s_sub_u32 s21, s76, s78
    s_min_u32 s81, s81, s21
    s_load_dword s74, s[72:73], 27648
    s_waitcnt lgkmcnt(0)
    s_memtime s[78:79]
    s_waitcnt lgkmcnt(0)
    s_sub_u32 s21, s78, s76
    s_min_u32 s83, s83, s21
    s_load_dword s74, s[72:73], 3072
    s_waitcnt lgkmcnt(0)
    s_memtime s[76:77]
    s_waitcnt lgkmcnt(0)
    s_sub_u32 s21, s76, s78
    s_min_u32 s80, s80, s21
    s_load_dword s74, s[72:73], 11264
    s_waitcnt lgkmcnt(0)
    s_memtime s[78:79]
    s_waitcnt lgkmcnt(0)
    s_sub_u32 s21, s78, s76
    s_min_u32 s81, s81, s21
    s_load_dword s74, s[72:73], 19456
    s_waitcnt lgkmcnt(0)
    s_memtime s[76:77]
    s_waitcnt lgkmcnt(0)
    s_sub_u32 s21, s76, s78
    s_min_u32 s82, s82, s21
    s_add_u32 s20, s80, s82
    s_add_u32 s21, s81, s83
    s_cmp_gt_u32 s20, s21
    s_cselect_b32 s22, 1, 0
    s_cselect_b32 s80, s81, s80
    s_cselect_b32 s82, s83, s82
    s_getreg_b32 s20, hwreg(HW_REG_XCC_ID, 2, 1)
    s_xor_b32 s20, s22, s20
    v_mov_b32 v4, s20
    v_mov_b32 v5, s6
    s_lshl_b32 s20, s65, 3
    s_add_u32 s20, s20, 86016
    v_mov_b32 v8, s20
    s_mov_b64 exec, 1
    global_store_dwordx2 v8, v[4:5], s[60:61] sc1
    s_mov_b64 exec, -1
    s_branch L_qpoll
L_m:
    s_mov_b32 s21, 98304
    v_mul_lo_u32 v1, v12, s21
    v_lshl_add_u32 v1, v13, 4, v1
    s_mul_i32 s20, s3, 786432
    s_add_u32 s26, s70, 2
    s_lshl_b32 s26, s26, 10
    s_lshl_b32 s21, s69, 7
    s_add_u32 s26, s26, s21
    s_add_u32 s20, s20, s26
    s_lshl_b32 s21, s3, 8
    v_lshl_add_u32 v14, v0, 2, s21
    s_mov_b32 s8, s54
    s_mov_b32 s9, s55
    s_mov_b32 s10, 3145728
    s_mov_b32 s11, 0x20000
    global_load_dword v15, v14, s[52:53]
    buffer_load_dwordx4 v[40:43], v1, s[8:11], s20 offen
    s_add_u32 s20, s20, 6144
    buffer_load_dwordx4 v[44:47], v1, s[8:11], s20 offen
    s_add_u32 s20, s20, 6144
    buffer_load_dwordx4 v[48:51], v1, s[8:11], s20 offen
    s_add_u32 s20, s20, 6144
    buffer_load_dwordx4 v[52:55], v1, s[8:11], s20 offen
    s_add_u32 s20, s20, 6144
    buffer_load_dwordx4 v[56:59], v1, s[8:11], s20 offen
    s_add_u32 s20, s20, 6144
    buffer_load_dwordx4 v[60:63], v1, s[8:11], s20 offen
    s_add_u32 s20, s20, 6144
    buffer_load_dwordx4 v[64:67], v1, s[8:11], s20 offen
    s_add_u32 s20, s20, 6144
    buffer_load_dwordx4 v[68:71], v1, s[8:11], s20 offen
    s_add_u32 s20, s20, 6144
    buffer_load_dwordx4 v[72:75], v1, s[8:11], s20 offen
    s_add_u32 s20, s20, 6144
    buffer_load_dwordx4 v[76:79], v1, s[8:11], s20 offen
    s_add_u32 s20, s20, 6144
    buffer_load_dwordx4 v[80:83], v1, s[8:11], s20 offen
    s_add_u32 s20, s20, 6144
    buffer_load_dwordx4 v[84:87], v1, s[8:11], s20 offen
    s_add_u32 s20, s20, 6144
    buffer_load_dwordx4 v[88:91], v1, s[8:11], s20 offen
    s_add_u32 s20, s20, 6144
    buffer_load_dwordx4 v[92:95], v1, s[8:11], s20 offen
    s_add_u32 s20, s20, 6144
    buffer_load_dwordx4 v[96:99], v1, s[8:11], s20 offen
    s_add_u32 s20, s20, 6144
    buffer_load_dwordx4 v[100:103], v1, s[8:11], s20 offen
    s_add_u32 s20, s20, 6144
    s_lshl_b32 s26, s26, 1
    s_add_u32 s26, s26, 12288
    s_waitcnt vmcnt(0)
    v_lshlrev_b32 v24, 16, v15
    v_and_b32 v25, 0xffff0000, v15
    s_mov_b32 s21, 0xbfb8aa3b
    v_mul_f32 v32, s21, v24
    v_mul_f32 v33, s21, v25
    v_exp_f32 v32, v32
    v_exp_f32 v33, v33
    v_add_f32 v32, 1.0, v32
    v_add_f32 v33, 1.0, v33
    v_rcp_f32 v32, v32
    v_rcp_f32 v33, v33
    v_mul_f32 v24, v24, v32
    v_mul_f32 v25, v25, v33
    v_perm_b32 v104, v44, v40, s24
    v_perm_b32 v105, v44, v40, s25
    v_perm_b32 v106, v45, v41, s24
    v_perm_b32 v107, v45, v41, s25
    v_perm_b32 v108, v46, v42, s24
    v_perm_b32 v109, v46, v42, s25
    v_perm_b32 v110, v47, v43, s24
    v_perm_b32 v111, v47, v43, s25
    v_perm_b32 v112, v52, v48, s24
    v_perm_b32 v113, v52, v48, s25
    v_perm_b32 v114, v53, v49, s24
    v_perm_b32 v115, v53, v49, s25
    v_perm_b32 v116, v54, v50, s24
    v_perm_b32 v117, v54, v50, s25
    v_perm_b32 v118, v55, v51, s24
    v_perm_b32 v119, v55, v51, s25
    v_perm_b32 v120, v60, v56, s24
    v_perm_b32 v121, v60, v56, s25
    v_perm_b32 v122, v61, v57, s24
    v_perm_b32 v123, v61, v57, s25
    v_perm_b32 v124, v62, v58, s24
    v_perm_b32 v125, v62, v58, s25
    v_perm_b32 v126, v63, v59, s24
    v_perm_b32 v127, v63, v59, s25
    v_perm_b32 v128, v68, v64, s24
    v_perm_b32 v129, v68, v64, s25
    v_perm_b32 v130, v69, v65, s24
    v_perm_b32 v131, v69, v65, s25
    v_perm_b32 v132, v70, v66, s24
    v_perm_b32 v133, v70, v66, s25
    v_perm_b32 v134, v71, v67, s24
    v_perm_b32 v135, v71, v67, s25
    v_perm_b32 v136, v76, v72, s24
    v_perm_b32 v137, v76, v72, s25
    v_perm_b32 v138, v77, v73, s24
    v_perm_b32 v139, v77, v73, s25
    v_perm_b32 v140, v78, v74, s24
    v_perm_b32 v141, v78, v74, s25
    v_perm_b32 v142, v79, v75, s24
    v_perm_b32 v143, v79, v75, s25
    v_perm_b32 v144, v84, v80, s24
    v_perm_b32 v145, v84, v80, s25
    v_perm_b32 v146, v85, v81, s24
    v_perm_b32 v147, v85, v81, s25
    v_perm_b32 v148, v86, v82, s24
    v_perm_b32 v149, v86, v82, s25
    v_perm_b32 v150, v87, v83, s24
    v_perm_b32 v151, v87, v83, s25
    v_perm_b32 v152, v92, v88, s24
    v_perm_b32 v153, v92, v88, s25
    v_perm_b32 v154, v93, v89, s24
    v_perm_b32 v155, v93, v89, s25
    v_perm_b32 v156, v94, v90, s24
    v_perm_b32 v157, v94, v90, s25
    v_perm_b32 v158, v95, v91, s24
    v_perm_b32 v159, v95, v91, s25
    v_perm_b32 v160, v100, v96, s24
    v_perm_b32 v161, v100, v96, s25
    v_perm_b32 v162, v101, v97, s24
    v_perm_b32 v163, v101, v97, s25
    v_perm_b32 v164, v102, v98, s24
    v_perm_b32 v165, v102, v98, s25
    v_perm_b32 v166, v103, v99, s24
    v_perm_b32 v167, v103, v99, s25
    s_branch L_gx
L_wb:
    s_cmp_lg_u32 s3, 0
    s_cbranch_scc1 L_wb1
    s_getreg_b32 s20, hwreg(HW_REG_XCC_ID, 0, 4)
    v_mov_b32 v4, s20
    v_mov_b32 v5, s6
    s_lshl_b32 s20, s4, 7
    s_lshl_b32 s21, s65, 3
    s_add_u32 s20, s20, s21
    s_add_u32 s20, s20, 81920
    v_mov_b32 v6, s20
    s_mov_b64 exec, 1
    global_store_dwordx2 v6, v[4:5], s[60:61] sc1
    s_mov_b64 exec, -1
    s_nop 0
L_wb1:
    s_mov_b32 s8, s44
    s_mov_b32 s9, s45
    s_mov_b32 s10, 4194304
    s_mov_b32 s11, 0x20000
    v_lshrrev_b32 v1, 3, v0
    v_lshlrev_b32 v1, 10, v1
    v_and_b32 v4, 7, v0
    v_lshl_add_u32 v1, v4, 4, v1
    s_lshl_b32 s20, s4, 19
    s_lshl_b32 s21, s3, 17
    s_add_u32 s20, s20, s21
    s_lshl_b32 s21, s65, 7
    s_add_u32 s20, s20, s21
    s_add_u32 s20, s20, 0
    s_lshl_b32 s23, s3, 14
    s_add_u32 s23, s23, 32768
    s_add_u32 m0, s23, 0
    s_nop 0
    buffer_load_dwordx4 v1, s[8:11], s20 offen  lds
    s_add_u32 s20, s20, 8192
    s_add_u32 m0, s23, 1024
    s_nop 0
    buffer_load_dwordx4 v1, s[8:11], s20 offen  lds
    s_add_u32 s20, s20, 8192
    s_add_u32 m0, s23, 2048
    s_nop 0
    buffer_load_dwordx4 v1, s[8:11], s20 offen  lds
    s_add_u32 s20, s20, 8192
    s_add_u32 m0, s23, 3072
    s_nop 0
    buffer_load_dwordx4 v1, s[8:11], s20 offen  lds
    s_add_u32 s20, s20, 8192
    s_add_u32 m0, s23, 4096
    s_nop 0
    buffer_load_dwordx4 v1, s[8:11], s20 offen  lds
    s_add_u32 s20, s20, 8192
    s_add_u32 m0, s23, 5120
    s_nop 0
    buffer_load_dwordx4 v1, s[8:11], s20 offen  lds
    s_add_u32 s20, s20, 8192
    s_add_u32 m0, s23, 6144
    s_nop 0
    buffer_load_dwordx4 v1, s[8:11], s20 offen  lds
    s_add_u32 s20, s20, 8192
    s_add_u32 m0, s23, 7168
    s_nop 0
    buffer_load_dwordx4 v1, s[8:11], s20 offen  lds
    s_add_u32 s20, s20, 8192
    s_add_u32 m0, s23, 8192
    s_nop 0
    buffer_load_dwordx4 v1, s[8:11], s20 offen  lds
    s_add_u32 s20, s20, 8192
    s_add_u32 m0, s23, 9216
    s_nop 0
    buffer_load_dwordx4 v1, s[8:11], s20 offen  lds
    s_add_u32 s20, s20, 8192
    s_add_u32 m0, s23, 10240
    s_nop 0
    buffer_load_dwordx4 v1, s[8:11], s20 offen  lds
    s_add_u32 s20, s20, 8192
    s_add_u32 m0, s23, 11264
    s_nop 0
    buffer_load_dwordx4 v1, s[8:11], s20 offen  lds
    s_add_u32 s20, s20, 8192
    s_add_u32 m0, s23, 12288
    s_nop 0
    buffer_load_dwordx4 v1, s[8:11], s20 offen  lds
    s_add_u32 s20, s20, 8192
    s_add_u32 m0, s23, 13312
    s_nop 0
    buffer_load_dwordx4 v1, s[8:11], s20 offen  lds
    s_add_u32 s20, s20, 8192
    s_add_u32 m0, s23, 14336
    s_nop 0
    buffer_load_dwordx4 v1, s[8:11], s20 offen  lds
    s_add_u32 s20, s20, 8192
    s_add_u32 m0, s23, 15360
    s_nop 0
    buffer_load_dwordx4 v1, s[8:11], s20 offen  lds
    s_add_u32 s20, s20, 8192
    s_lshl_b32 s23, s3, 14
    s_add_u32 s23, s23, 32768
    v_bfe_u32 v1, v0, 2, 2
    v_lshlrev_b32 v1, 10, v1
    v_lshrrev_b32 v4, 4, v0
    v_lshl_add_u32 v1, v4, 12, v1
    v_and_b32 v4, 3, v0
    v_lshl_add_u32 v1, v4, 3, v1
    v_add_u32 v1, s23, v1
    s_waitcnt vmcnt(0)
    ds_read_b64_tr_b16 v[104:105], v1 offset:0
    ds_read_b64_tr_b16 v[106:107], v1 offset:512
    ds_read_b64_tr_b16 v[108:109], v1 offset:32
    ds_read_b64_tr_b16 v[110:111], v1 offset:544
    ds_read_b64_tr_b16 v[112:113], v1 offset:64
    ds_read_b64_tr_b16 v[114:115], v1 offset:576
    ds_read_b64_tr_b16 v[116:117], v1 offset:96
    ds_read_b64_tr_b16 v[118:119], v1 offset:608
    ds_read_b64_tr_b16 v[120:121], v1 offset:128
    ds_read_b64_tr_b16 v[122:123], v1 offset:640
    ds_read_b64_tr_b16 v[124:125], v1 offset:160
    ds_read_b64_tr_b16 v[126:127], v1 offset:672
    s_waitcnt lgkmcnt(8)
    ds_read_b64_tr_b16 v[128:129], v1 offset:192
    ds_read_b64_tr_b16 v[130:131], v1 offset:704
    ds_read_b64_tr_b16 v[132:133], v1 offset:224
    ds_read_b64_tr_b16 v[134:135], v1 offset:736
    s_waitcnt lgkmcnt(8)
    ds_read_b64_tr_b16 v[136:137], v1 offset:256
    ds_read_b64_tr_b16 v[138:139], v1 offset:768
    ds_read_b64_tr_b16 v[140:141], v1 offset:288
    ds_read_b64_tr_b16 v[142:143], v1 offset:800
    s_waitcnt lgkmcnt(8)
    ds_read_b64_tr_b16 v[144:145], v1 offset:320
    ds_read_b64_tr_b16 v[146:147], v1 offset:832
    ds_read_b64_tr_b16 v[148:149], v1 offset:352
    ds_read_b64_tr_b16 v[150:151], v1 offset:864
    s_waitcnt lgkmcnt(8)
    ds_read_b64_tr_b16 v[152:153], v1 offset:384
    ds_read_b64_tr_b16 v[154:155], v1 offset:896
    ds_read_b64_tr_b16 v[156:157], v1 offset:416
    ds_read_b64_tr_b16 v[158:159], v1 offset:928
    s_waitcnt lgkmcnt(8)
    ds_read_b64_tr_b16 v[160:161], v1 offset:448
    ds_read_b64_tr_b16 v[162:163], v1 offset:960
    ds_read_b64_tr_b16 v[164:165], v1 offset:480
    ds_read_b64_tr_b16 v[166:167], v1 offset:992
    s_waitcnt lgkmcnt(8)
    s_waitcnt lgkmcnt(0)
L_qpoll:
    s_cmp_lg_u32 s66, 2
    s_cbranch_scc1 L_qp1
    s_mov_b32 s26, s67
    s_mov_b32 s8, s48
    s_mov_b32 s9, s49
    s_mov_b32 s10, 1835008
    s_mov_b32 s11, 0x20000
    v_lshrrev_b32 v1, 2, v0
    s_mov_b32 s20, 3584
    v_mul_lo_u32 v1, v1, s20
    v_and_b32 v12, 3, v0
    v_lshl_add_u32 v1, v12, 4, v1
    s_mul_i32 s20, s3, 458752
    s_lshl_b32 s21, s26, 6
    s_add_u32 s20, s20, s21
    s_lshl_b32 s23, s3, 14
    s_add_u32 s23, s23, 32768
    s_add_u32 m0, s23, 0
    s_nop 0
    buffer_load_dwordx4 v1, s[8:11], s20 offen  lds
    s_add_u32 s20, s20, 57344
    s_add_u32 m0, s23, 1024
    s_nop 0
    buffer_load_dwordx4 v1, s[8:11], s20 offen  lds
    s_add_u32 s20, s20, 57344
    s_add_u32 m0, s23, 2048
    s_nop 0
    buffer_load_dwordx4 v1, s[8:11], s20 offen  lds
    s_add_u32 s20, s20, 57344
    s_add_u32 m0, s23, 3072
    s_nop 0
    buffer_load_dwordx4 v1, s[8:11], s20 offen  lds
    s_add_u32 s20, s20, 57344
    s_add_u32 m0, s23, 4096
    s_nop 0
    buffer_load_dwordx4 v1, s[8:11], s20 offen  lds
    s_add_u32 s20, s20, 57344
    s_add_u32 m0, s23, 5120
    s_nop 0
    buffer_load_dwordx4 v1, s[8:11], s20 offen  lds
    s_add_u32 s20, s20, 57344
    s_add_u32 m0, s23, 6144
    s_nop 0
    buffer_load_dwordx4 v1, s[8:11], s20 offen  lds
    s_add_u32 s20, s20, 57344
    s_add_u32 m0, s23, 7168
    s_nop 0
    buffer_load_dwordx4 v1, s[8:11], s20 offen  lds
    s_add_u32 s20, s20, 57344
L_qp1:
    v_mov_b32 v10, 0
    v_mov_b32 v23, 0
    v_mov_b32 v35, 64
    s_cmp_lg_u32 s3, 1
    s_cbranch_scc1 L_np
    s_lshl_b32 s21, s4, 11
    s_add_u32 s21, s21, 32768
    v_add_u32 v14, s21, v2
    s_mov_b32 s7, 1777777
L_sk_13:
    ds_read_b32 v11, v10 offset:20
    s_waitcnt lgkmcnt(0)
    v_cmp_gt_u32 vcc, 1, v11
    s_cbranch_vccz L_skd_14
    s_sleep 16
    s_sub_u32 s7, s7, 1
    s_cbranch_scc0 L_sk_13
L_skd_14:
    s_mov_b32 s7, 5333333
L_pq_15:
    ds_read_b32 v11, v10 offset:20
    s_waitcnt lgkmcnt(0)
    v_readfirstlane_b32 s21, v11
    s_nop 0
    s_lshr_b32 s21, s21, 1
    s_and_b32 s21, s21, s7
    s_cselect_b32 s21, 0, 32768
    v_add_u32 v15, s21, v14
    global_load_dwordx4 v[16:19], v15, s[60:61] offset:0 sc1
    global_load_dwordx4 v[20:23], v15, s[60:61] offset:1024 sc1
    s_waitcnt vmcnt(0)
    v_xor_b32 v4, s6, v17
    v_xor_b32 v5, s6, v19
    v_or_b32 v4, v4, v5
    v_xor_b32 v5, s6, v21
    v_or_b32 v4, v4, v5
    v_xor_b32 v5, s6, v23
    v_or_b32 v4, v4, v5
    v_cmp_ne_u32 vcc, 0, v4
    s_cbranch_vccz L_pqd_16
    s_mov_b64 exec, vcc
    s_sleep 2
    s_sub_u32 s7, s7, 1
    s_cbranch_scc0 L_pq_15
L_pqd_16:
    s_mov_b64 exec, -1
    v_mov_b32 v17, v18
    v_mov_b32 v21, v22
    v_lshlrev_b32 v14, 3, v0
    v_mov_b32 v5, 1
    ds_write_b64 v14, v[16:17] offset:1024
    ds_write_b64 v14, v[20:21] offset:1536
    ds_write_b32 v10, v5 offset:4
L_np:
    s_cmp_eq_u32 s3, 2
    s_cbranch_scc1 L_post
    s_cmp_eq_u32 s66, 0
    s_cbranch_scc1 L_done
    s_cmp_lg_u32 s66, 3
    s_cbranch_scc1 L_ws
    s_cmp_lg_u32 s3, 0
    s_cbranch_scc1 L_done
L_ws:
    s_mov_b32 s7, 941176
L_ss0_17:
    ds_read_b32 v11, v10 offset:8
    s_waitcnt lgkmcnt(0)
    v_cmp_gt_u32 vcc, 9, v11
    s_cbranch_vccz L_ss0d_18
    s_sleep 32
    s_sub_u32 s7, s7, 1
    s_cbranch_scc0 L_ss0_17
L_ss0d_18:
    s_branch L_pre
L_done:
    s_endpgm
L_post:
    s_lshl_b32 s20, s4, 15
    s_lshr_b32 s19, s5, 4
    s_lshl_b32 s19, s19, 10
    s_add_u32 s20, s20, s19
    s_and_b32 s19, s5, 15
    s_lshl_b32 s19, s19, 4
    s_add_u32 s20, s20, s19
    s_add_u32 s20, s20, 1048576
    v_and_b32 v37, 3, v0
    v_lshlrev_b32 v37, 13, v37
    v_bfe_u32 v15, v0, 2, 2
    v_lshl_add_u32 v37, v15, 11, v37
    v_lshrrev_b32 v15, 4, v0
    v_lshl_add_u32 v37, v15, 8, v37
    v_add_u32 v37, s20, v37
    v_bfe_u32 v36, v0, 2, 2
    v_mov_b32 v16, -1
    v_mov_b32 v17, -1
    v_mov_b32 v18, -1
    v_mov_b32 v19, -1
    v_and_b32 v20, 7, v0
    s_lshl_b32 s20, s4, 7
    s_add_u32 s20, s20, 81920
    v_lshl_add_u32 v20, v20, 3, s20
    s_mov_b32 s7, 941176
L_sg_19:
    ds_read_b32 v11, v10 offset:20
    s_waitcnt lgkmcnt(0)
    v_cmp_gt_u32 vcc, 1, v11
    s_cbranch_vccz L_sgd_20
    s_sleep 32
    s_sub_u32 s7, s7, 1
    s_cbranch_scc0 L_sg_19
L_sgd_20:
    s_mov_b32 s7, 2666666
L_px_21:
    global_load_dwordx2 v[22:23], v20, s[60:61] sc1
    s_waitcnt vmcnt(0)
    v_xor_b32 v21, s6, v23
    v_cmp_ne_u32 vcc, 0, v21
    s_cbranch_vccz L_pxd_22
    s_mov_b64 exec, vcc
    s_sleep 8
    s_sub_u32 s7, s7, 1
    s_cbranch_scc0 L_px_21
L_pxd_22:
    s_mov_b64 exec, -1
    s_getreg_b32 s20, hwreg(HW_REG_XCC_ID, 0, 4)
    v_cmp_ne_u32 vcc, s20, v22
    s_cbranch_vccz L_ng
    v_mov_b32 v5, 1
    ds_write_b32 v10, v5 offset:64
    global_store_dwordx4 v37, v[16:19], s[60:61] sc1
L_ng:
    v_add_u32 v39, 262144, v37
    global_store_dwordx4 v39, v[16:19], s[60:61]
    v_lshlrev_b32 v38, 3, v36
    v_mov_b32 v5, 1
    s_lshl_b32 s20, s4, 11
    s_lshl_b32 s21, s5, 4
    s_add_u32 s20, s20, s21
    s_add_u32 s20, s20, 49152
    v_lshl_add_u32 v36, v36, 9, s20
    s_waitcnt vmcnt(0)
    s_mov_b64 exec, 1
    ds_add_u32 v10, v5 offset:8
    s_mov_b64 exec, -1
    s_mov_b32 s7, 1777777
L_ss_23:
    ds_read_b32 v11, v10 offset:8
    s_waitcnt lgkmcnt(0)
    v_cmp_gt_u32 vcc, 9, v11
    s_cbranch_vccz L_ssd_24
    s_sleep 16
    s_sub_u32 s7, s7, 1
    s_cbranch_scc0 L_ss_23
L_ssd_24:
    ds_read_b64 v[40:41], v38 offset:256
    ds_read_b64 v[42:43], v38 offset:288
    ds_read_b64 v[44:45], v38 offset:320
    ds_read_b64 v[46:47], v38 offset:352
    ds_read_b64 v[48:49], v38 offset:384
    ds_read_b64 v[50:51], v38 offset:416
    ds_read_b64 v[52:53], v38 offset:448
    ds_read_b64 v[54:55], v38 offset:480
    s_waitcnt lgkmcnt(0)
    v_max3_f32 v56, v40, v42, v44
    v_max3_f32 v56, v56, v46, v48
    v_max3_f32 v56, v56, v50, v52
    v_max_f32 v56, v56, v54
    v_sub_f32 v28, v40, v56
    v_sub_f32 v29, v42, v56
    v_sub_f32 v30, v44, v56
    v_sub_f32 v31, v46, v56
    v_sub_f32 v32, v48, v56
    v_sub_f32 v33, v50, v56
    v_sub_f32 v34, v52, v56
    v_sub_f32 v35, v54, v56
    v_exp_f32 v28, v28
    v_exp_f32 v29, v29
    v_exp_f32 v30, v30
    v_exp_f32 v31, v31
    v_exp_f32 v32, v32
    v_exp_f32 v33, v33
    v_exp_f32 v34, v34
    v_exp_f32 v35, v35
    v_mul_f32 v58, v28, v41
    v_fmac_f32 v58, v29, v43
    v_fmac_f32 v58, v30, v45
    v_fmac_f32 v58, v31, v47
    v_fmac_f32 v58, v32, v49
    v_fmac_f32 v58, v33, v51
    v_fmac_f32 v58, v34, v53
    v_fmac_f32 v58, v35, v55
    s_getreg_b32 s20, hwreg(HW_REG_XCC_ID, 0, 4)
    s_add_u32 s20, s20, s6
    v_mov_b32 v57, s6
    v_mov_b32 v59, s20
    s_mov_b64 exec, 0x1111
    global_store_dwordx4 v36, v[56:59], s[60:61] sc1
    s_mov_b64 exec, -1
    s_cmp_eq_u32 s66, 0
    s_cbranch_scc1 L_done
    s_cmp_eq_u32 s66, 3
    s_cbranch_scc1 L_done
L_pre:
    v_and_b32 v37, 7, v0
    v_lshlrev_b32 v37, 3, v37
    v_add_u32 v37, 86016, v37
    s_cmp_eq_u32 s66, 3
    s_cbranch_scc1 L_tf
    s_cmp_eq_u32 s66, 2
    s_cbranch_scc1 L_tc
    s_lshl_b32 s20, s4, 11
    s_lshl_b32 s21, s3, 9
    s_add_u32 s20, s20, s21
    s_add_u32 s20, s20, 49152
    v_and_b32 v4, 31, v0
    v_lshl_add_u32 v5, v4, 4, s20
    s_mov_b32 s7, 2285714
L_sb_25:
    ds_read_b32 v11, v10 offset:24
    s_waitcnt lgkmcnt(0)
    v_cmp_gt_u32 vcc, 6, v11
    s_cbranch_vccz L_sbd_26
    s_sleep 12
    s_sub_u32 s7, s7, 1
    s_cbranch_scc0 L_sb_25
L_sbd_26:
    s_mov_b32 s7, 2666666
L_ps_27:
    global_load_dwordx4 v[40:43], v5, s[60:61] sc1
    global_load_dwordx2 v[38:39], v37, s[60:61] sc1
    s_waitcnt vmcnt(0)
    v_subrev_u32 v43, s6, v43
    v_xor_b32 v6, s6, v41
    v_lshrrev_b32 v7, 4, v43
    v_or_b32 v6, v6, v7
    v_xor_b32 v7, s6, v39
    v_or_b32 v6, v6, v7
    v_cmp_ne_u32 vcc, 0, v6
    s_cbranch_vccz L_psd_28
    s_mov_b64 exec, vcc
    s_sleep 8
    s_sub_u32 s7, s7, 1
    s_cbranch_scc0 L_ps_27
L_psd_28:
    s_mov_b64 exec, -1
    v_and_b32 v37, 1, v38
    v_cmp_ne_u32 vcc, 0, v37
    s_nop 0
    s_and_b32 s71, vcc_lo, 0xff
    s_bcnt1_i32_b32 s71, s71
    s_cmp_gt_u32 s71, 4
    s_cselect_b32 s71, 0x2000, 0
    s_or_b32 s71, s71, 0
    s_xor_b32 s75, s71, 0x4000
    s_getreg_b32 s20, hwreg(HW_REG_XCC_ID, 0, 4)
    v_cmp_eq_u32 vcc, s20, v43
    s_nop 0
    s_and_b32 s28, vcc_lo, 0xffff
    s_mul_i32 s28, s28, 0x10001
    s_mov_b32 s29, s28
    s_lshr_b32 s30, vcc_lo, 16
    s_mul_i32 s30, s30, 0x10001
    s_mov_b32 s31, s30
    v_mov_b32 v44, v40
    s_nop 1
    v_max_f32_dpp v44, v44, v44 row_ror:8 row_mask:0xf bank_mask:0xf
    s_nop 1
    v_max_f32_dpp v44, v44, v44 row_ror:4 row_mask:0xf bank_mask:0xf
    s_nop 1
    v_max_f32_dpp v44, v44, v44 row_ror:2 row_mask:0xf bank_mask:0xf
    s_nop 1
    v_max_f32_dpp v44, v44, v44 row_ror:1 row_mask:0xf bank_mask:0xf
    v_mov_b32 v45, v44
    s_nop 1
    v_permlane16_swap_b32 v44, v45
    v_max_f32 v44, v44, v45
    v_sub_f32 v40, v40, v44
    v_exp_f32 v40, v40
    s_nop 0
    v_mul_f32 v44, v40, v42
    s_nop 1
    v_add_f32_dpp v44, v44, v44 row_ror:8 row_mask:0xf bank_mask:0xf
    s_nop 1
    v_add_f32_dpp v44, v44, v44 row_ror:4 row_mask:0xf bank_mask:0xf
    s_nop 1
    v_add_f32_dpp v44, v44, v44 row_ror:2 row_mask:0xf bank_mask:0xf
    s_nop 1
    v_add_f32_dpp v44, v44, v44 row_ror:1 row_mask:0xf bank_mask:0xf
    v_mov_b32 v45, v44
    s_nop 1
    v_permlane16_swap_b32 v44, v45
    v_add_f32 v44, v44, v45
    v_rcp_f32 v44, v44
    s_nop 0
    v_mul_f32 v40, v40, v44
    s_lshl_b32 s20, s3, 8
    v_lshl_add_u32 v4, v4, 2, s20
    v_lshrrev_b32 v5, 4, v0
    v_lshl_add_u32 v5, v5, 4, s20
    ds_write_b32 v4, v40 offset:3072
    ds_read_b128 v[12:15], v5 offset:3072
    ds_read_b128 v[16:19], v5 offset:3136
    v_and_b32 v1, 15, v0
    v_lshrrev_b32 v4, 4, v0
    v_lshlrev_b32 v24, 4, v1
    v_lshl_add_u32 v22, v4, 14, v24
    v_lshlrev_b32 v1, 6, v1
    v_lshl_add_u32 v1, v4, 4, v1
    s_lshl_b32 s20, s4, 15
    s_lshl_b32 s21, s3, 13
    s_add_u32 s20, s20, s21
    s_add_u32 s20, s20, 1048576
    v_add_u32 v1, s20, v2
    v_add_u32 v5, 262144, v1
    v_cndmask_b32 v6, v1, v5, s[28:29]
    v_cndmask_b32 v7, v1, v5, s[30:31]
    v_add_u32 v8, 4096, v6
    v_add_u32 v9, 4096, v7
    s_lshl_b32 s20, s3, 8
    v_lshl_add_u32 v21, v0, 2, s20
    s_and_b32 s20, s4, 3
    s_lshl_b32 s20, s20, 11
    s_lshr_b32 s21, s4, 2
    s_lshl_b32 s21, s21, 15
    s_add_u32 s20, s20, s21
    s_lshl_b32 s21, s67, 8
    s_add_u32 s20, s20, s21
    s_add_u32 s20, s20, 262144
    v_bfe_u32 v22, v0, 4, 1
    v_lshl_add_u32 v22, v22, 16, v24
    v_lshrrev_b32 v25, 5, v0
    v_lshl_add_u32 v22, v25, 13, v22
    v_add_u32 v22, s20, v22
    v_xor_b32 v22, s71, v22
    s_waitcnt lgkmcnt(0)
    s_mov_b64 s[80:81], -1
    s_mov_b32 s7, 8000000
    s_mov_b64 s[32:33], -1
    s_mov_b64 s[34:35], -1
L_pa:
    s_mov_b64 exec, s[32:33]
    global_load_dwordx4 v[40:43], v6, s[60:61] offset:0 sc1
    global_load_dwordx4 v[44:47], v6, s[60:61] offset:2048 sc1
    global_load_dwordx4 v[48:51], v8, s[60:61] offset:0 sc1
    global_load_dwordx4 v[52:55], v8, s[60:61] offset:2048 sc1
    s_mov_b64 exec, s[34:35]
    global_load_dwordx4 v[56:59], v7, s[60:61] offset:1024 sc1
    global_load_dwordx4 v[60:63], v7, s[60:61] offset:3072 sc1
    global_load_dwordx4 v[64:67], v9, s[60:61] offset:1024 sc1
    global_load_dwordx4 v[68:71], v9, s[60:61] offset:3072 sc1
    s_mov_b64 exec, -1
L_pa2:
    s_waitcnt vmcnt(4)
    v_max3_u32 v23, v40, v41, v42
    v_max3_u32 v23, v23, v43, v44
    v_max3_u32 v23, v23, v45, v46
    v_max3_u32 v23, v23, v47, v48
    v_max3_u32 v23, v23, v49, v50
    v_max3_u32 v23, v23, v51, v52
    v_max3_u32 v23, v23, v53, v54
    v_max_u32 v23, v23, v55
    v_cmp_eq_u32 vcc, -1, v23
    s_nop 0
    s_mov_b64 s[32:33], vcc
    s_waitcnt vmcnt(0)
    v_max3_u32 v23, v56, v57, v58
    v_max3_u32 v23, v23, v59, v60
    v_max3_u32 v23, v23, v61, v62
    v_max3_u32 v23, v23, v63, v64
    v_max3_u32 v23, v23, v65, v66
    v_max3_u32 v23, v23, v67, v68
    v_max3_u32 v23, v23, v69, v70
    v_max_u32 v23, v23, v71
    v_cmp_eq_u32 vcc, -1, v23
    s_nop 0
    s_mov_b64 s[34:35], vcc
    s_cbranch_vccz L_pa1
    s_cmp_eq_u64 s[32:33], 0
    s_cbranch_scc1 L_pa0
    s_sub_u32 s7, s7, 1
    s_cbranch_scc0 L_pa
L_pa0:
    s_cmp_eq_u64 s[34:35], 0
    s_cbranch_scc1 L_pb0
    s_mov_b64 exec, s[34:35]
    global_load_dwordx4 v[56:59], v7, s[60:61] offset:1024 sc1
    global_load_dwordx4 v[60:63], v7, s[60:61] offset:3072 sc1
    global_load_dwordx4 v[64:67], v9, s[60:61] offset:1024 sc1
    global_load_dwordx4 v[68:71], v9, s[60:61] offset:3072 sc1
    s_mov_b64 exec, -1
L_pb0:
    v_mfma_f32_16x16x32_bf16 v[72:75], v[40:43], v[104:107], 0
    v_mfma_f32_16x16x32_bf16 v[80:83], v[40:43], v[112:115], 0
    v_mfma_f32_16x16x32_bf16 v[76:79], v[40:43], v[108:111], 0
    v_mfma_f32_16x16x32_bf16 v[84:87], v[40:43], v[116:119], 0
    v_mfma_f32_16x16x32_bf16 v[72:75], v[44:47], v[120:123], v[72:75]
    v_mfma_f32_16x16x32_bf16 v[80:83], v[44:47], v[128:131], v[80:83]
    v_mfma_f32_16x16x32_bf16 v[76:79], v[44:47], v[124:127], v[76:79]
    v_mfma_f32_16x16x32_bf16 v[84:87], v[44:47], v[132:135], v[84:87]
    v_mfma_f32_16x16x32_bf16 v[72:75], v[48:51], v[136:139], v[72:75]
    v_mfma_f32_16x16x32_bf16 v[80:83], v[48:51], v[144:147], v[80:83]
    v_mfma_f32_16x16x32_bf16 v[76:79], v[48:51], v[140:143], v[76:79]
    v_mfma_f32_16x16x32_bf16 v[84:87], v[48:51], v[148:151], v[84:87]
    v_mfma_f32_16x16x32_bf16 v[72:75], v[52:55], v[152:155], v[72:75]
    v_mfma_f32_16x16x32_bf16 v[80:83], v[52:55], v[160:163], v[80:83]
    v_mfma_f32_16x16x32_bf16 v[76:79], v[52:55], v[156:159], v[76:79]
    v_mfma_f32_16x16x32_bf16 v[84:87], v[52:55], v[164:167], v[84:87]
    s_nop 4
    v_pk_mul_f32 v[72:73], v[72:73], v[12:13]
    v_pk_mul_f32 v[80:81], v[80:81], v[12:13]
    v_pk_mul_f32 v[76:77], v[76:77], v[12:13]
    v_pk_mul_f32 v[84:85], v[84:85], v[12:13]
    v_pk_fma_f32 v[72:73], v[74:75], v[14:15], v[72:73]
    v_pk_fma_f32 v[80:81], v[82:83], v[14:15], v[80:81]
    v_pk_fma_f32 v[76:77], v[78:79], v[14:15], v[76:77]
    v_pk_fma_f32 v[84:85], v[86:87], v[14:15], v[84:85]
    v_add_f32 v72, v72, v73
    v_add_f32 v80, v80, v81
    v_add_f32 v76, v76, v77
    v_add_f32 v84, v84, v85
    s_mov_b64 exec, s[34:35]
    s_cbranch_execz L_pd0
L_pc0:
    s_waitcnt vmcnt(0)
    v_max3_u32 v23, v56, v57, v58
    v_max3_u32 v23, v23, v59, v60
    v_max3_u32 v23, v23, v61, v62
    v_max3_u32 v23, v23, v63, v64
    v_max3_u32 v23, v23, v65, v66
    v_max3_u32 v23, v23, v67, v68
    v_max3_u32 v23, v23, v69, v70
    v_max_u32 v23, v23, v71
    v_cmp_eq_u32 vcc, -1, v23
    s_cbranch_vccz L_pd0
    s_mov_b64 exec, vcc
    global_load_dwordx4 v[56:59], v7, s[60:61] offset:1024 sc1
    global_load_dwordx4 v[60:63], v7, s[60:61] offset:3072 sc1
    global_load_dwordx4 v[64:67], v9, s[60:61] offset:1024 sc1
    global_load_dwordx4 v[68:71], v9, s[60:61] offset:3072 sc1
    s_sub_u32 s7, s7, 1
    s_cbranch_scc0 L_pc0
    s_waitcnt vmcnt(0)
L_pd0:
    s_mov_b64 exec, s[80:81]
    v_mfma_f32_16x16x32_bf16 v[88:91], v[56:59], v[104:107], 0
    v_mfma_f32_16x16x32_bf16 v[96:99], v[56:59], v[112:115], 0
    v_mfma_f32_16x16x32_bf16 v[92:95], v[56:59], v[108:111], 0
    v_mfma_f32_16x16x32_bf16 v[100:103], v[56:59], v[116:119], 0
    v_mfma_f32_16x16x32_bf16 v[88:91], v[60:63], v[120:123], v[88:91]
    v_mfma_f32_16x16x32_bf16 v[96:99], v[60:63], v[128:131], v[96:99]
    v_mfma_f32_16x16x32_bf16 v[92:95], v[60:63], v[124:127], v[92:95]
    v_mfma_f32_16x16x32_bf16 v[100:103], v[60:63], v[132:135], v[100:103]
    v_mfma_f32_16x16x32_bf16 v[88:91], v[64:67], v[136:139], v[88:91]
    v_mfma_f32_16x16x32_bf16 v[96:99], v[64:67], v[144:147], v[96:99]
    v_mfma_f32_16x16x32_bf16 v[92:95], v[64:67], v[140:143], v[92:95]
    v_mfma_f32_16x16x32_bf16 v[100:103], v[64:67], v[148:151], v[100:103]
    v_mfma_f32_16x16x32_bf16 v[88:91], v[68:71], v[152:155], v[88:91]
    v_mfma_f32_16x16x32_bf16 v[96:99], v[68:71], v[160:163], v[96:99]
    v_mfma_f32_16x16x32_bf16 v[92:95], v[68:71], v[156:159], v[92:95]
    v_mfma_f32_16x16x32_bf16 v[100:103], v[68:71], v[164:167], v[100:103]
    s_nop 4
    v_pk_mul_f32 v[88:89], v[88:89], v[16:17]
    v_pk_mul_f32 v[96:97], v[96:97], v[16:17]
    v_pk_mul_f32 v[92:93], v[92:93], v[16:17]
    v_pk_mul_f32 v[100:101], v[100:101], v[16:17]
    v_pk_fma_f32 v[88:89], v[90:91], v[18:19], v[88:89]
    v_pk_fma_f32 v[96:97], v[98:99], v[18:19], v[96:97]
    v_pk_fma_f32 v[92:93], v[94:95], v[18:19], v[92:93]
    v_pk_fma_f32 v[100:101], v[102:103], v[18:19], v[100:101]
    v_add_f32 v88, v88, v89
    v_add_f32 v96, v96, v97
    v_add_f32 v92, v92, v93
    v_add_f32 v100, v100, v101
    v_add_f32 v72, v72, v88
    v_add_f32 v80, v80, v96
    v_add_f32 v76, v76, v92
    v_add_f32 v84, v84, v100
    v_permlane32_swap_b32 v72, v80
    v_add_f32 v72, v72, v80
    s_branch L_pe
L_pa1:
    s_cmp_eq_u64 s[32:33], 0
    s_cbranch_scc1 L_pb1
    s_mov_b64 exec, s[32:33]
    global_load_dwordx4 v[40:43], v6, s[60:61] offset:0 sc1
    global_load_dwordx4 v[44:47], v6, s[60:61] offset:2048 sc1
    global_load_dwordx4 v[48:51], v8, s[60:61] offset:0 sc1
    global_load_dwordx4 v[52:55], v8, s[60:61] offset:2048 sc1
    s_mov_b64 exec, -1
L_pb1:
    v_mfma_f32_16x16x32_bf16 v[88:91], v[56:59], v[104:107], 0
    v_mfma_f32_16x16x32_bf16 v[96:99], v[56:59], v[112:115], 0
    v_mfma_f32_16x16x32_bf16 v[92:95], v[56:59], v[108:111], 0
    v_mfma_f32_16x16x32_bf16 v[100:103], v[56:59], v[116:119], 0
    v_mfma_f32_16x16x32_bf16 v[88:91], v[60:63], v[120:123], v[88:91]
    v_mfma_f32_16x16x32_bf16 v[96:99], v[60:63], v[128:131], v[96:99]
    v_mfma_f32_16x16x32_bf16 v[92:95], v[60:63], v[124:127], v[92:95]
    v_mfma_f32_16x16x32_bf16 v[100:103], v[60:63], v[132:135], v[100:103]
    v_mfma_f32_16x16x32_bf16 v[88:91], v[64:67], v[136:139], v[88:91]
    v_mfma_f32_16x16x32_bf16 v[96:99], v[64:67], v[144:147], v[96:99]
    v_mfma_f32_16x16x32_bf16 v[92:95], v[64:67], v[140:143], v[92:95]
    v_mfma_f32_16x16x32_bf16 v[100:103], v[64:67], v[148:151], v[100:103]
    v_mfma_f32_16x16x32_bf16 v[88:91], v[68:71], v[152:155], v[88:91]
    v_mfma_f32_16x16x32_bf16 v[96:99], v[68:71], v[160:163], v[96:99]
    v_mfma_f32_16x16x32_bf16 v[92:95], v[68:71], v[156:159], v[92:95]
    v_mfma_f32_16x16x32_bf16 v[100:103], v[68:71], v[164:167], v[100:103]
    s_nop 4
    v_pk_mul_f32 v[88:89], v[88:89], v[16:17]
    v_pk_mul_f32 v[96:97], v[96:97], v[16:17]
    v_pk_mul_f32 v[92:93], v[92:93], v[16:17]
    v_pk_mul_f32 v[100:101], v[100:101], v[16:17]
    v_pk_fma_f32 v[88:89], v[90:91], v[18:19], v[88:89]
    v_pk_fma_f32 v[96:97], v[98:99], v[18:19], v[96:97]
    v_pk_fma_f32 v[92:93], v[94:95], v[18:19], v[92:93]
    v_pk_fma_f32 v[100:101], v[102:103], v[18:19], v[100:101]
    v_add_f32 v88, v88, v89
    v_add_f32 v96, v96, v97
    v_add_f32 v92, v92, v93
    v_add_f32 v100, v100, v101
    s_mov_b64 exec, s[32:33]
    s_cbranch_execz L_pd1
L_pc1:
    s_waitcnt vmcnt(0)
    v_max3_u32 v23, v40, v41, v42
    v_max3_u32 v23, v23, v43, v44
    v_max3_u32 v23, v23, v45, v46
    v_max3_u32 v23, v23, v47, v48
    v_max3_u32 v23, v23, v49, v50
    v_max3_u32 v23, v23, v51, v52
    v_max3_u32 v23, v23, v53, v54
    v_max_u32 v23, v23, v55
    v_cmp_eq_u32 vcc, -1, v23
    s_cbranch_vccz L_pd1
    s_mov_b64 exec, vcc
    global_load_dwordx4 v[40:43], v6, s[60:61] offset:0 sc1
    global_load_dwordx4 v[44:47], v6, s[60:61] offset:2048 sc1
    global_load_dwordx4 v[48:51], v8, s[60:61] offset:0 sc1
    global_load_dwordx4 v[52:55], v8, s[60:61] offset:2048 sc1
    s_sub_u32 s7, s7, 1
    s_cbranch_scc0 L_pc1
    s_waitcnt vmcnt(0)
L_pd1:
    s_mov_b64 exec, s[80:81]
    v_mfma_f32_16x16x32_bf16 v[72:75], v[40:43], v[104:107], 0
    v_mfma_f32_16x16x32_bf16 v[80:83], v[40:43], v[112:115], 0
    v_mfma_f32_16x16x32_bf16 v[76:79], v[40:43], v[108:111], 0
    v_mfma_f32_16x16x32_bf16 v[84:87], v[40:43], v[116:119], 0
    v_mfma_f32_16x16x32_bf16 v[72:75], v[44:47], v[120:123], v[72:75]
    v_mfma_f32_16x16x32_bf16 v[80:83], v[44:47], v[128:131], v[80:83]
    v_mfma_f32_16x16x32_bf16 v[76:79], v[44:47], v[124:127], v[76:79]
    v_mfma_f32_16x16x32_bf16 v[84:87], v[44:47], v[132:135], v[84:87]
    v_mfma_f32_16x16x32_bf16 v[72:75], v[48:51], v[136:139], v[72:75]
    v_mfma_f32_16x16x32_bf16 v[80:83], v[48:51], v[144:147], v[80:83]
    v_mfma_f32_16x16x32_bf16 v[76:79], v[48:51], v[140:143], v[76:79]
    v_mfma_f32_16x16x32_bf16 v[84:87], v[48:51], v[148:151], v[84:87]
    v_mfma_f32_16x16x32_bf16 v[72:75], v[52:55], v[152:155], v[72:75]
    v_mfma_f32_16x16x32_bf16 v[80:83], v[52:55], v[160:163], v[80:83]
    v_mfma_f32_16x16x32_bf16 v[76:79], v[52:55], v[156:159], v[76:79]
    v_mfma_f32_16x16x32_bf16 v[84:87], v[52:55], v[164:167], v[84:87]
    s_nop 4
    v_pk_mul_f32 v[72:73], v[72:73], v[12:13]
    v_pk_mul_f32 v[80:81], v[80:81], v[12:13]
    v_pk_mul_f32 v[76:77], v[76:77], v[12:13]
    v_pk_mul_f32 v[84:85], v[84:85], v[12:13]
    v_pk_fma_f32 v[72:73], v[74:75], v[14:15], v[72:73]
    v_pk_fma_f32 v[80:81], v[82:83], v[14:15], v[80:81]
    v_pk_fma_f32 v[76:77], v[78:79], v[14:15], v[76:77]
    v_pk_fma_f32 v[84:85], v[86:87], v[14:15], v[84:85]
    v_add_f32 v72, v72, v73
    v_add_f32 v80, v80, v81
    v_add_f32 v76, v76, v77
    v_add_f32 v84, v84, v85
    v_add_f32 v72, v72, v88
    v_add_f32 v80, v80, v96
    v_add_f32 v76, v76, v92
    v_add_f32 v84, v84, v100
    v_permlane32_swap_b32 v72, v80
    v_add_f32 v72, v72, v80
L_pe:
    s_nop 0
    v_permlane32_swap_b32 v76, v84
    v_add_f32 v76, v76, v84
    s_nop 1
    v_permlane16_swap_b32 v72, v76
    v_add_f32 v72, v72, v76
    ds_write_b32 v21, v72 offset:4096
    s_waitcnt lgkmcnt(0)
    s_barrier
    s_cmp_ge_u32 s3, 1
    s_cbranch_scc1 L_done
L_bnb:
    ds_read_b128 v[88:91], v24 offset:4096
    ds_read_b128 v[92:95], v24 offset:4352
    ds_read_b128 v[96:99], v24 offset:4608
    ds_read_b128 v[100:103], v24 offset:4864
    s_waitcnt lgkmcnt(2)
    v_pk_add_f32 v[88:89], v[88:89], v[92:93]
    v_pk_add_f32 v[90:91], v[90:91], v[94:95]
    s_waitcnt lgkmcnt(0)
    v_pk_add_f32 v[96:97], v[96:97], v[100:101]
    v_pk_add_f32 v[98:99], v[98:99], v[102:103]
    v_pk_add_f32 v[88:89], v[88:89], v[96:97]
    v_pk_add_f32 v[90:91], v[90:91], v[98:99]
    global_store_dwordx4 v22, v[88:91], s[60:61] sc1
    s_endpgm
L_tc:
    s_mov_b32 s26, s67
    s_mov_b32 s8, s48
    s_mov_b32 s9, s49
    s_mov_b32 s10, 1835008
    s_mov_b32 s11, 0x20000
    s_mov_b32 s12, s50
    s_mov_b32 s13, s51
    s_mov_b32 s14, 1835008
    s_mov_b32 s15, 0x20000
    v_lshrrev_b32 v23, 4, v0
    v_lshlrev_b32 v23, 4, v23
    v_lshrrev_b32 v1, 2, v0
    s_mov_b32 s20, 3584
    v_mul_lo_u32 v1, v1, s20
    v_and_b32 v12, 3, v0
    v_lshl_add_u32 v1, v12, 4, v1
    s_mul_i32 s20, s3, 458752
    s_lshl_b32 s21, s26, 6
    s_add_u32 s20, s20, s21
    v_lshlrev_b32 v18, 6, v23
    v_and_b32 v13, 15, v0
    v_lshl_add_u32 v18, v13, 4, v18
    s_lshl_b32 s27, s26, 15
    s_lshl_b32 s21, s3, 8
    s_add_u32 s27, s27, s21
    s_lshl_b32 s23, s3, 14
    s_add_u32 s23, s23, 32768
    v_lshrrev_b32 v12, 4, v0
    v_bfe_u32 v13, v0, 2, 2
    v_and_b32 v14, 3, v0
    v_lshl_add_u32 v14, v14, 3, s23
    v_lshl_add_u32 v1, v12, 9, v14
    v_lshl_add_u32 v1, v13, 6, v1
    v_lshl_add_u32 v19, v12, 10, v14
    v_lshl_add_u32 v19, v13, 8, v19
    v_and_b32 v20, 31, v0
    v_lshlrev_b32 v20, 3, v20
    v_lshrrev_b32 v21, 5, v0
    v_lshl_add_u32 v20, v21, 2, v20
    s_lshl_b32 s20, s3, 8
    v_add_u32 v20, s20, v20
    global_load_dword v22, v20, s[36:37]
    global_load_dwordx4 v[28:31], v2, s[36:37]
    v_lshlrev_b32 v21, 1, v20
    v_add_u32 v21, 16384, v21
    v_add_u32 v24, 4096, v21
    s_mov_b32 s7, 1600000
L_pm_29:
    global_load_dwordx2 v[40:41], v21, s[60:61] sc1
    global_load_dwordx2 v[42:43], v21, s[60:61] offset:2048 sc1
    global_load_dwordx2 v[44:45], v24, s[60:61] sc1
    global_load_dwordx2 v[38:39], v37, s[60:61] sc1
    s_waitcnt vmcnt(0)
    v_xor_b32 v46, s6, v41
    v_xor_b32 v47, s6, v43
    v_or_b32 v46, v46, v47
    v_xor_b32 v47, s6, v45
    v_or_b32 v46, v46, v47
    v_xor_b32 v47, s6, v39
    v_or_b32 v46, v46, v47
    v_cmp_ne_u32 vcc, 0, v46
    s_cbranch_vccz L_pmd_30
    s_mov_b64 exec, vcc
    s_sleep 16
    s_sub_u32 s7, s7, 1
    s_cbranch_scc0 L_pm_29
L_pmd_30:
    s_mov_b64 exec, -1
    v_and_b32 v37, 1, v38
    v_cmp_ne_u32 vcc, 0, v37
    s_nop 0
    s_and_b32 s71, vcc_lo, 0xff
    s_bcnt1_i32_b32 s71, s71
    s_cmp_gt_u32 s71, 4
    s_cselect_b32 s71, 0x2000, 0
    s_or_b32 s71, s71, 0
    s_xor_b32 s75, s71, 0x4000
    ds_read_b64_tr_b16 v[104:105], v1 offset:0
    ds_read_b64_tr_b16 v[106:107], v1 offset:256
    ds_read_b64_tr_b16 v[108:109], v1 offset:32
    ds_read_b64_tr_b16 v[110:111], v1 offset:288
    ds_read_b64_tr_b16 v[112:113], v1 offset:2048
    ds_read_b64_tr_b16 v[114:115], v1 offset:2304
    ds_read_b64_tr_b16 v[116:117], v1 offset:2080
    ds_read_b64_tr_b16 v[118:119], v1 offset:2336
    s_waitcnt lgkmcnt(0)
    ds_read_b64_tr_b16 v[120:121], v1 offset:4096
    ds_read_b64_tr_b16 v[122:123], v1 offset:4352
    ds_read_b64_tr_b16 v[124:125], v1 offset:4128
    ds_read_b64_tr_b16 v[126:127], v1 offset:4384
    ds_read_b64_tr_b16 v[128:129], v1 offset:6144
    ds_read_b64_tr_b16 v[130:131], v1 offset:6400
    ds_read_b64_tr_b16 v[132:133], v1 offset:6176
    ds_read_b64_tr_b16 v[134:135], v1 offset:6432
    s_waitcnt lgkmcnt(0)
    v_lshlrev_b32 v4, 16, v22
    v_and_b32 v5, 0xffff0000, v22
    v_lshlrev_b32 v48, 16, v28
    v_and_b32 v49, 0xffff0000, v28
    v_lshlrev_b32 v50, 16, v29
    v_and_b32 v51, 0xffff0000, v29
    v_lshlrev_b32 v52, 16, v30
    v_and_b32 v53, 0xffff0000, v30
    v_lshlrev_b32 v54, 16, v31
    v_and_b32 v55, 0xffff0000, v31
    v_pk_add_f32 v[48:49], v[48:49], v[50:51]
    v_pk_add_f32 v[52:53], v[52:53], v[54:55]
    v_pk_add_f32 v[48:49], v[48:49], v[52:53]
    v_add_f32 v48, v48, v49
    s_nop 1
    v_add_f32_dpp v48, v48, v48 row_ror:8 row_mask:0xf bank_mask:0xf
    s_nop 1
    v_add_f32_dpp v48, v48, v48 row_ror:4 row_mask:0xf bank_mask:0xf
    s_nop 1
    v_add_f32_dpp v48, v48, v48 row_ror:2 row_mask:0xf bank_mask:0xf
    s_nop 1
    v_add_f32_dpp v48, v48, v48 row_ror:1 row_mask:0xf bank_mask:0xf
    v_mov_b32 v49, v48
    s_nop 1
    v_permlane16_swap_b32 v48, v49
    v_add_f32 v48, v48, v49
    v_mov_b32 v49, v48
    s_nop 1
    v_permlane32_swap_b32 v48, v49
    v_add_f32 v48, v48, v49
    v_mul_f32 v48, 0x3b000000, v48
    v_sub_f32 v4, v4, v48
    v_sub_f32 v5, v5, v48
    v_lshlrev_b32 v6, 16, v40
    v_and_b32 v7, 0xffff0000, v40
    v_lshlrev_b32 v8, 16, v44
    v_and_b32 v9, 0xffff0000, v44
    v_add_f32 v8, 1.0, v8
    v_add_f32 v9, 1.0, v9
    v_cvt_pk_bf16_f32 v44, v8, v9
    v_lshlrev_b32 v8, 16, v44
    v_and_b32 v9, 0xffff0000, v44
    ds_write_b32 v20, v44 offset:5120
    ds_write_b32 v20, v42 offset:6144
    v_add_u32 v21, s20, v23
    v_and_b32 v22, 1, v0
    v_lshl_add_u32 v22, v22, 10, v21
    ds_read_b128 v[48:51], v22 offset:5120
    ds_read_b128 v[52:55], v22 offset:5184
    ds_read_b128 v[56:59], v22 offset:5248
    ds_read_b128 v[60:63], v22 offset:5312
    s_waitcnt lgkmcnt(0)
    v_mfma_f32_16x16x32_bf16 v[24:27], v[104:107], v[48:51], 0
    v_mfma_f32_16x16x32_bf16 v[28:31], v[108:111], v[48:51], 0
    v_mfma_f32_16x16x32_bf16 v[24:27], v[112:115], v[52:55], v[24:27]
    v_mfma_f32_16x16x32_bf16 v[28:31], v[116:119], v[52:55], v[28:31]
    v_mfma_f32_16x16x32_bf16 v[24:27], v[120:123], v[56:59], v[24:27]
    v_mfma_f32_16x16x32_bf16 v[28:31], v[124:127], v[56:59], v[28:31]
    v_mfma_f32_16x16x32_bf16 v[24:27], v[128:131], v[60:63], v[24:27]
    v_mfma_f32_16x16x32_bf16 v[28:31], v[132:135], v[60:63], v[28:31]
    s_mov_b32 exec_lo, 0x00030003
    s_mov_b32 exec_hi, 0x00030003
    s_nop 4
    ds_write_b128 v22, v[24:27] offset:8192
    ds_write_b128 v22, v[28:31] offset:8256
    s_mov_b64 exec, 1
    v_mov_b32 v33, 1
    ds_add_u32 v10, v33 offset:16
    s_mov_b64 exec, -1
    v_and_b32 v1, 31, v0
    v_lshlrev_b32 v1, 4, v1
    v_lshrrev_b32 v16, 5, v0
    v_lshl_add_u32 v1, v16, 11, v1
    s_bfe_u32 s20, s4, 0x10001
    s_lshl_b32 s20, s20, 16
    s_lshr_b32 s21, s4, 2
    s_lshl_b32 s21, s21, 13
    s_xor_b32 s21, s21, s71
    s_add_u32 s20, s20, s21
    s_add_u32 s20, s20, 262144
    s_lshl_b32 s21, s3, 9
    s_add_u32 s20, s20, s21
    v_add_u32 v1, s20, v1
    v_add_u32 v12, 4096, v1
    v_add_u32 v13, 32768, v1
    v_add_u32 v14, 36864, v1
    s_lshl_b32 s20, s3, 8
    v_lshl_add_u32 v22, v16, 2, s20
    v_and_b32 v33, 3, v0
    v_lshlrev_b32 v33, 8, v33
    v_bfe_u32 v32, v0, 3, 1
    v_lshl_add_u32 v32, v32, 6, v33
    v_add_u32 v32, v32, v23
    s_mov_b32 s22, 0x3b000000
    v_mov_b32 v34, 0x3727c5ac
    s_mov_b32 s7, 5333333
L_sp_31:
    ds_read_b32 v11, v10 offset:16
    ds_read_b128 v[24:27], v32 offset:8192
    ds_read_b128 v[28:31], v32 offset:9216
    s_waitcnt lgkmcnt(0)
    v_cmp_gt_u32 vcc, 4, v11
    s_cbranch_vccz L_spd_32
    s_sleep 4
    s_sub_u32 s7, s7, 1
    s_cbranch_scc0 L_sp_31
L_spd_32:
    v_add_f32_dpp v24, v24, v24 quad_perm:[1,0,3,2] row_mask:0xf bank_mask:0xf
    v_add_f32_dpp v25, v25, v25 quad_perm:[1,0,3,2] row_mask:0xf bank_mask:0xf
    v_add_f32_dpp v26, v26, v26 quad_perm:[1,0,3,2] row_mask:0xf bank_mask:0xf
    v_add_f32_dpp v27, v27, v27 quad_perm:[1,0,3,2] row_mask:0xf bank_mask:0xf
    v_add_f32_dpp v28, v28, v28 quad_perm:[1,0,3,2] row_mask:0xf bank_mask:0xf
    v_add_f32_dpp v29, v29, v29 quad_perm:[1,0,3,2] row_mask:0xf bank_mask:0xf
    v_add_f32_dpp v30, v30, v30 quad_perm:[1,0,3,2] row_mask:0xf bank_mask:0xf
    v_add_f32_dpp v31, v31, v31 quad_perm:[1,0,3,2] row_mask:0xf bank_mask:0xf
    v_add_f32_dpp v24, v24, v24 quad_perm:[2,3,0,1] row_mask:0xf bank_mask:0xf
    v_add_f32_dpp v25, v25, v25 quad_perm:[2,3,0,1] row_mask:0xf bank_mask:0xf
    v_add_f32_dpp v26, v26, v26 quad_perm:[2,3,0,1] row_mask:0xf bank_mask:0xf
    v_add_f32_dpp v27, v27, v27 quad_perm:[2,3,0,1] row_mask:0xf bank_mask:0xf
    v_add_f32_dpp v28, v28, v28 quad_perm:[2,3,0,1] row_mask:0xf bank_mask:0xf
    v_add_f32_dpp v29, v29, v29 quad_perm:[2,3,0,1] row_mask:0xf bank_mask:0xf
    v_add_f32_dpp v30, v30, v30 quad_perm:[2,3,0,1] row_mask:0xf bank_mask:0xf
    v_add_f32_dpp v31, v31, v31 quad_perm:[2,3,0,1] row_mask:0xf bank_mask:0xf
    s_mov_b64 s[80:81], -1
    s_mov_b32 s82, 0x00010001
    s_mov_b32 s83, 0x00010001
    s_mov_b32 s7, 1777777
L_sv0_33:
    ds_read_b32 v11, v10 offset:24
    s_waitcnt lgkmcnt(0)
    v_cmp_gt_u32 vcc, 4, v11
    s_cbranch_vccz L_sv0d_34
    s_sleep 16
    s_sub_u32 s7, s7, 1
    s_cbranch_scc0 L_sv0_33
L_sv0d_34:
    s_mov_b32 s7, 8000000
L_sv_35:
    ds_read_b32 v11, v10 offset:12
    s_waitcnt lgkmcnt(0)
    v_cmp_gt_u32 vcc, 1, v11
    s_cbranch_vccz L_svd_36
    s_sleep 2
    s_sub_u32 s7, s7, 1
    s_cbranch_scc0 L_sv_35
L_svd_36:
    s_add_u32 s23, s23, 8192
    s_add_u32 m0, s23, 0
    s_nop 0
    buffer_load_dwordx4 v18, s[12:15], s27 offen  lds
    s_add_u32 s27, s27, 4096
    s_add_u32 m0, s23, 1024
    s_nop 0
    buffer_load_dwordx4 v18, s[12:15], s27 offen  lds
    s_add_u32 s27, s27, 4096
    s_add_u32 m0, s23, 2048
    s_nop 0
    buffer_load_dwordx4 v18, s[12:15], s27 offen  lds
    s_add_u32 s27, s27, 4096
    s_add_u32 m0, s23, 3072
    s_nop 0
    buffer_load_dwordx4 v18, s[12:15], s27 offen  lds
    s_add_u32 s27, s27, 4096
    s_add_u32 m0, s23, 4096
    s_nop 0
    buffer_load_dwordx4 v18, s[12:15], s27 offen  lds
    s_add_u32 s27, s27, 4096
    s_add_u32 m0, s23, 5120
    s_nop 0
    buffer_load_dwordx4 v18, s[12:15], s27 offen  lds
    s_add_u32 s27, s27, 4096
    s_add_u32 m0, s23, 6144
    s_nop 0
    buffer_load_dwordx4 v18, s[12:15], s27 offen  lds
    s_add_u32 s27, s27, 4096
    s_add_u32 m0, s23, 7168
    s_nop 0
    buffer_load_dwordx4 v18, s[12:15], s27 offen  lds
    s_add_u32 s27, s27, 4096
    s_and_b32 s20, s3, 1
    s_lshl_b32 s20, s20, 18
    s_lshr_b32 s21, s3, 1
    s_lshl_b32 s21, s21, 13
    s_xor_b32 s21, s21, s75
    s_add_u32 s20, s20, s21
    s_lshl_b32 s21, s26, 7
    s_add_u32 s20, s20, s21
    s_add_u32 s20, s20, 524288
    v_bfe_u32 v35, v0, 2, 3
    v_lshlrev_b32 v35, 15, v35
    v_and_b32 v36, 3, v0
    v_lshl_add_u32 v35, v36, 4, v35
    v_add_u32 v35, s20, v35
    s_waitcnt vmcnt(0)
    ds_read_b64_tr_b16 v[136:137], v19 offset:8192
    ds_read_b64_tr_b16 v[138:139], v19 offset:12288
    ds_read_b64_tr_b16 v[140:141], v19 offset:8224
    ds_read_b64_tr_b16 v[142:143], v19 offset:12320
    ds_read_b64_tr_b16 v[144:145], v19 offset:8256
    ds_read_b64_tr_b16 v[146:147], v19 offset:12352
    ds_read_b64_tr_b16 v[148:149], v19 offset:8288
    ds_read_b64_tr_b16 v[150:151], v19 offset:12384
    s_waitcnt lgkmcnt(0)
    ds_read_b64_tr_b16 v[152:153], v19 offset:8320
    ds_read_b64_tr_b16 v[154:155], v19 offset:12416
    ds_read_b64_tr_b16 v[156:157], v19 offset:8352
    ds_read_b64_tr_b16 v[158:159], v19 offset:12448
    ds_read_b64_tr_b16 v[160:161], v19 offset:8384
    ds_read_b64_tr_b16 v[162:163], v19 offset:12480
    ds_read_b64_tr_b16 v[164:165], v19 offset:8416
    ds_read_b64_tr_b16 v[166:167], v19 offset:12512
    s_waitcnt lgkmcnt(0)
    s_mov_b32 s7, 8000000
    global_load_dwordx4 v[88:91], v1, s[60:61] sc1
    global_load_dwordx4 v[92:95], v12, s[60:61] sc1
    global_load_dwordx4 v[96:99], v13, s[60:61] sc1
    global_load_dwordx4 v[100:103], v14, s[60:61] sc1
L_pbt:
    s_waitcnt vmcnt(0)
    v_max3_u32 v56, v88, v89, v90
    v_max3_u32 v57, v92, v93, v94
    v_max3_u32 v58, v96, v97, v98
    v_max3_u32 v59, v100, v101, v102
    v_max_u32 v56, v56, v91
    v_max_u32 v57, v57, v95
    v_max_u32 v58, v58, v99
    v_max_u32 v59, v59, v103
    v_max3_u32 v60, v56, v57, v58
    v_max_u32 v60, v60, v59
    v_cmp_eq_u32 vcc, -1, v60
    s_cbranch_vccz L_pbd
    v_cmp_eq_u32 s[28:29], -1, v56
    v_cmp_eq_u32 s[30:31], -1, v57
    v_cmp_eq_u32 s[32:33], -1, v58
    v_cmp_eq_u32 s[34:35], -1, v59
    s_or_b64 exec, s[28:29], 1
    global_load_dwordx4 v[88:91], v1, s[60:61] sc1
    s_or_b64 exec, s[30:31], 1
    global_load_dwordx4 v[92:95], v12, s[60:61] sc1
    s_or_b64 exec, s[32:33], 1
    global_load_dwordx4 v[96:99], v13, s[60:61] sc1
    s_or_b64 exec, s[34:35], 1
    global_load_dwordx4 v[100:103], v14, s[60:61] sc1
    s_mov_b64 exec, -1
    s_sub_u32 s7, s7, 1
    s_cbranch_scc0 L_pbt
L_pbd:
    v_pk_add_f32 v[40:41], v[88:89], v[92:93]
    v_pk_add_f32 v[42:43], v[90:91], v[94:95]
    v_pk_add_f32 v[48:49], v[96:97], v[100:101]
    v_pk_add_f32 v[50:51], v[98:99], v[102:103]
    v_pk_add_f32 v[40:41], v[40:41], v[48:49]
    v_pk_add_f32 v[42:43], v[42:43], v[50:51]
    s_nop 1
    v_permlane32_swap_b32 v40, v42
    v_permlane32_swap_b32 v41, v43
    v_pk_add_f32 v[40:41], v[40:41], v[42:43]
    v_pk_fma_f32 v[4:5], v[40:41], v[6:7], v[4:5]
    v_pk_mul_f32 v[6:7], v[4:5], v[8:9]
    v_cvt_pk_bf16_f32 v6, v6, v7
    ds_write_b32 v20, v6 offset:5120
    ds_read_b128 v[44:47], v21 offset:5120
    ds_read_b128 v[48:51], v21 offset:5184
    ds_read_b128 v[52:55], v21 offset:5248
    ds_read_b128 v[56:59], v21 offset:5312
    v_add_f32 v16, v4, v5
    v_mul_f32 v17, v4, v4
    v_fmac_f32 v17, v5, v5
    s_nop 1
    v_permlane32_swap_b32 v16, v17
    v_add_f32 v16, v16, v17
    v_mov_b32 v17, v16
    s_nop 1
    v_permlane16_swap_b32 v16, v17
    v_add_f32 v16, v16, v17
    s_waitcnt lgkmcnt(3)
    v_mfma_f32_16x16x32_bf16 v[60:63], v[104:107], v[44:47], 0
    v_mfma_f32_16x16x32_bf16 v[64:67], v[108:111], v[44:47], 0
    v_add_f32_dpp v16, v16, v16 row_ror:8 row_mask:0xf bank_mask:0xf
    s_waitcnt lgkmcnt(2)
    v_mfma_f32_16x16x32_bf16 v[60:63], v[112:115], v[48:51], v[60:63]
    v_mfma_f32_16x16x32_bf16 v[64:67], v[116:119], v[48:51], v[64:67]
    v_add_f32_dpp v16, v16, v16 row_ror:4 row_mask:0xf bank_mask:0xf
    s_waitcnt lgkmcnt(1)
    v_mfma_f32_16x16x32_bf16 v[60:63], v[120:123], v[52:55], v[60:63]
    v_mfma_f32_16x16x32_bf16 v[64:67], v[124:127], v[52:55], v[64:67]
    v_add_f32_dpp v16, v16, v16 row_ror:2 row_mask:0xf bank_mask:0xf
    s_waitcnt lgkmcnt(0)
    v_mfma_f32_16x16x32_bf16 v[60:63], v[128:131], v[56:59], v[60:63]
    v_mfma_f32_16x16x32_bf16 v[64:67], v[132:135], v[56:59], v[64:67]
    v_add_f32_dpp v16, v16, v16 row_ror:1 row_mask:0xf bank_mask:0xf
    s_mov_b64 exec, s[82:83]
    ds_write_b32 v22, v16 offset:4224
    s_nop 3
    ds_write_b128 v21, v[60:63] offset:4096
    ds_write_b128 v21, v[64:67] offset:4160
    s_mov_b64 exec, s[80:81]
    s_waitcnt lgkmcnt(0)
    s_barrier
L_cnb:
    ds_read_b64 v[12:13], v33 offset:4224
    ds_read_b128 v[40:43], v32 offset:4096
    s_waitcnt lgkmcnt(0)
    v_add_f32_dpp v12, v12, v12 quad_perm:[1,0,3,2] row_mask:0xf bank_mask:0xf
    v_add_f32_dpp v13, v13, v13 quad_perm:[1,0,3,2] row_mask:0xf bank_mask:0xf
    v_add_f32_dpp v40, v40, v40 quad_perm:[1,0,3,2] row_mask:0xf bank_mask:0xf
    v_add_f32_dpp v41, v41, v41 quad_perm:[1,0,3,2] row_mask:0xf bank_mask:0xf
    v_add_f32_dpp v42, v42, v42 quad_perm:[1,0,3,2] row_mask:0xf bank_mask:0xf
    v_add_f32_dpp v43, v43, v43 quad_perm:[1,0,3,2] row_mask:0xf bank_mask:0xf
    v_add_f32_dpp v12, v12, v12 quad_perm:[2,3,0,1] row_mask:0xf bank_mask:0xf
    v_add_f32_dpp v13, v13, v13 quad_perm:[2,3,0,1] row_mask:0xf bank_mask:0xf
    v_add_f32_dpp v40, v40, v40 quad_perm:[2,3,0,1] row_mask:0xf bank_mask:0xf
    v_add_f32_dpp v41, v41, v41 quad_perm:[2,3,0,1] row_mask:0xf bank_mask:0xf
    v_add_f32_dpp v42, v42, v42 quad_perm:[2,3,0,1] row_mask:0xf bank_mask:0xf
    v_add_f32_dpp v43, v43, v43 quad_perm:[2,3,0,1] row_mask:0xf bank_mask:0xf
    v_mul_f32 v12, s22, v12
    v_fma_f32 v14, v13, s22, v34
    v_fma_f32 v14, -v12, v12, v14
    v_max_f32 v14, v14, v34
    v_rsq_f32 v14, v14
    v_pk_fma_f32 v[40:41], v[24:25], v[12:13], v[40:41] op_sel_hi:[1,0,1] neg_lo:[0,1,0] neg_hi:[0,1,0]
    v_pk_fma_f32 v[42:43], v[26:27], v[12:13], v[42:43] op_sel_hi:[1,0,1] neg_lo:[0,1,0] neg_hi:[0,1,0]
    v_pk_fma_f32 v[40:41], v[40:41], v[14:15], v[28:29] op_sel_hi:[1,0,1]
    v_pk_fma_f32 v[42:43], v[42:43], v[14:15], v[30:31] op_sel_hi:[1,0,1]
    v_cvt_pk_bf16_f32 v48, v40, v41
    v_cvt_pk_bf16_f32 v49, v42, v43
    v_pk_max_i16 v48, v48, 0
    v_pk_max_i16 v49, v49, 0
    s_nop 0
    v_mov_b32_dpp v50, v48 row_shl:8 row_mask:0xf bank_mask:0xf bound_ctrl:0
    v_mov_b32_dpp v51, v49 row_shl:8 row_mask:0xf bank_mask:0xf bound_ctrl:0
    s_nop 1
    v_mfma_f32_16x16x32_bf16 v[56:59], v[48:51], v[136:139], 0
    v_mfma_f32_16x16x32_bf16 v[64:67], v[48:51], v[144:147], 0
    v_mfma_f32_16x16x32_bf16 v[72:75], v[48:51], v[152:155], 0
    v_mfma_f32_16x16x32_bf16 v[80:83], v[48:51], v[160:163], 0
    v_mfma_f32_16x16x32_bf16 v[60:63], v[48:51], v[140:143], 0
    v_mfma_f32_16x16x32_bf16 v[68:71], v[48:51], v[148:151], 0
    v_mfma_f32_16x16x32_bf16 v[76:79], v[48:51], v[156:159], 0
    v_mfma_f32_16x16x32_bf16 v[84:87], v[48:51], v[164:167], 0
    s_nop 1
    v_mov_b32 v57, v64
    v_mov_b32 v58, v72
    v_mov_b32 v59, v80
    v_mov_b32_dpp v56, v60 quad_perm:[0,1,2,3] row_mask:0x2 bank_mask:0xf
    v_mov_b32_dpp v57, v68 quad_perm:[0,1,2,3] row_mask:0x2 bank_mask:0xf
    v_mov_b32_dpp v58, v76 quad_perm:[0,1,2,3] row_mask:0x2 bank_mask:0xf
    v_mov_b32_dpp v59, v84 quad_perm:[0,1,2,3] row_mask:0x2 bank_mask:0xf
    s_mov_b32 exec_hi, 0
    global_store_dwordx4 v35, v[56:59], s[60:61] sc1
    s_endpgm
L_tf:
    s_mov_b32 s26, s67
    s_lshr_b32 s20, s26, 3
    s_lshl_b32 s20, s20, 7
    s_and_b32 s21, s26, 7
    s_lshl_b32 s21, s21, 2
    s_add_u32 s20, s20, s21
    v_and_b32 v4, 3, v0
    v_lshrrev_b32 v5, 4, v0
    v_lshl_add_u32 v4, v5, 5, v4
    v_add_u32 v4, s20, v4
    v_lshlrev_b32 v5, 1, v4
    global_load_ushort v8, v5, s[36:37]
    v_lshrrev_b32 v6, 1, v4
    v_lshlrev_b32 v6, 3, v6
    v_add_u32 v6, 16384, v6
    v_add_u32 v7, 6144, v6
    s_mov_b32 s7, 1600000
L_pg_37:
    global_load_dwordx2 v[12:13], v6, s[60:61] sc1
    global_load_dwordx2 v[14:15], v7, s[60:61] sc1
    global_load_dwordx2 v[38:39], v37, s[60:61] sc1
    s_waitcnt vmcnt(0)
    v_xor_b32 v16, s6, v13
    v_xor_b32 v17, s6, v15
    v_or_b32 v16, v16, v17
    v_xor_b32 v17, s6, v39
    v_or_b32 v16, v16, v17
    v_cmp_ne_u32 vcc, 0, v16
    s_cbranch_vccz L_pgd_38
    s_mov_b64 exec, vcc
    s_sleep 16
    s_sub_u32 s7, s7, 1
    s_cbranch_scc0 L_pg_37
L_pgd_38:
    s_mov_b64 exec, -1
    v_and_b32 v37, 1, v38
    v_cmp_ne_u32 vcc, 0, v37
    s_nop 0
    s_and_b32 s71, vcc_lo, 0xff
    s_bcnt1_i32_b32 s71, s71
    s_cmp_gt_u32 s71, 4
    s_cselect_b32 s71, 0x2000, 0
    s_or_b32 s71, s71, 0
    s_xor_b32 s75, s71, 0x4000
    v_lshlrev_b32 v8, 16, v8
    v_and_b32 v16, 1, v4
    v_cmp_eq_u32 vcc, 0, v16
    v_lshlrev_b32 v16, 16, v12
    v_and_b32 v17, 0xffff0000, v12
    v_cndmask_b32 v9, v17, v16, vcc
    v_lshlrev_b32 v16, 16, v14
    v_and_b32 v17, 0xffff0000, v14
    v_cndmask_b32 v12, v17, v16, vcc
    s_bfe_u32 s20, s4, 0x10001
    s_lshl_b32 s20, s20, 16
    s_lshr_b32 s21, s4, 2
    s_lshl_b32 s21, s21, 13
    s_xor_b32 s21, s21, s71
    s_add_u32 s20, s20, s21
    s_add_u32 s20, s20, 262144
    v_bfe_u32 v6, v0, 2, 1
    v_lshlrev_b32 v6, 12, v6
    v_bfe_u32 v7, v0, 3, 1
    v_lshl_add_u32 v6, v7, 15, v6
    v_lshl_add_u32 v6, v4, 2, v6
    v_add_u32 v6, s20, v6
    s_and_b32 s20, s26, 15
    s_lshl_b32 s20, s20, 15
    s_lshr_b32 s21, s26, 4
    s_lshl_b32 s21, s21, 13
    s_xor_b32 s21, s21, s75
    s_add_u32 s20, s20, s21
    s_add_u32 s20, s20, 524288
    v_lshrrev_b32 v7, 2, v0
    v_lshl_add_u32 v7, v7, 6, v2
    v_add_u32 v7, s20, v7
    v_add_u32 v32, 4096, v7
    s_mov_b32 s7, 1777777
L_sf_39:
    ds_read_b32 v11, v10 offset:12
    s_waitcnt lgkmcnt(0)
    v_cmp_gt_u32 vcc, 1, v11
    s_cbranch_vccz L_sfd_40
    s_sleep 16
    s_sub_u32 s7, s7, 1
    s_cbranch_scc0 L_sf_39
L_sfd_40:
    s_mov_b32 s7, 6400000
L_pxb_41:
    global_load_dword v13, v6, s[60:61] sc1
    global_load_dword v14, v6, s[60:61] offset:2048 sc1
    s_waitcnt vmcnt(0)
    v_max_u32 v15, v13, v14
    v_cmp_eq_u32 vcc, -1, v15
    s_cbranch_vccz L_pxbd_42
    s_mov_b64 exec, vcc
    s_sleep 1
    s_sub_u32 s7, s7, 1
    s_cbranch_scc0 L_pxb_41
L_pxbd_42:
    s_mov_b64 exec, -1
    v_add_f32 v13, v13, v14
    s_nop 1
    v_add_f32_dpp v13, v13, v13 row_ror:8 row_mask:0xf bank_mask:0xf
    s_nop 1
    v_add_f32_dpp v13, v13, v13 row_ror:4 row_mask:0xf bank_mask:0xf
    v_fma_f32 v8, v9, v13, v8
    s_mov_b32 s7, 8000000
    global_load_dwordx4 v[40:43], v7, s[60:61] offset:0 sc1
    global_load_dwordx4 v[44:47], v7, s[60:61] offset:2048 sc1
    global_load_dwordx4 v[48:51], v32, s[60:61] offset:0 sc1
    global_load_dwordx4 v[52:55], v32, s[60:61] offset:2048 sc1
L_pct:
    s_waitcnt vmcnt(0)
    v_max3_u32 v56, v40, v41, v42
    v_max3_u32 v57, v44, v45, v46
    v_max3_u32 v58, v48, v49, v50
    v_max3_u32 v59, v52, v53, v54
    v_max_u32 v56, v56, v43
    v_max_u32 v57, v57, v47
    v_max_u32 v58, v58, v51
    v_max_u32 v59, v59, v55
    v_max3_u32 v60, v56, v57, v58
    v_max_u32 v60, v60, v59
    v_cmp_eq_u32 vcc, -1, v60
    s_cbranch_vccz L_pcd
    v_cmp_eq_u32 s[28:29], -1, v56
    v_cmp_eq_u32 s[30:31], -1, v57
    v_cmp_eq_u32 s[32:33], -1, v58
    v_cmp_eq_u32 s[34:35], -1, v59
    s_or_b64 exec, s[28:29], 1
    global_load_dwordx4 v[40:43], v7, s[60:61] offset:0 sc1
    s_or_b64 exec, s[30:31], 1
    global_load_dwordx4 v[44:47], v7, s[60:61] offset:2048 sc1
    s_or_b64 exec, s[32:33], 1
    global_load_dwordx4 v[48:51], v32, s[60:61] offset:0 sc1
    s_or_b64 exec, s[34:35], 1
    global_load_dwordx4 v[52:55], v32, s[60:61] offset:2048 sc1
    s_mov_b64 exec, -1
    s_sub_u32 s7, s7, 1
    s_cbranch_scc0 L_pct
L_pcd:
L_fd:
    v_pk_add_f32 v[16:17], v[40:41], v[44:45]
    v_pk_add_f32 v[18:19], v[42:43], v[46:47]
    v_pk_add_f32 v[24:25], v[48:49], v[52:53]
    v_pk_add_f32 v[26:27], v[50:51], v[54:55]
    v_pk_add_f32 v[16:17], v[16:17], v[24:25]
    v_pk_add_f32 v[18:19], v[18:19], v[26:27]
    s_nop 1
    v_permlane32_swap_b32 v16, v18
    v_permlane32_swap_b32 v17, v19
    v_pk_add_f32 v[16:17], v[16:17], v[18:19]
    s_nop 1
    v_permlane16_swap_b32 v16, v17
    v_add_f32 v16, v16, v17
    s_nop 1
    v_add_f32_dpp v16, v16, v16 row_ror:8 row_mask:0xf bank_mask:0xf
    s_nop 1
    v_add_f32_dpp v16, v16, v16 row_ror:4 row_mask:0xf bank_mask:0xf
    v_fma_f32 v16, v12, v16, v8
    v_cvt_pk_bf16_f32 v16, v16, v16
    s_mov_b32 exec_lo, 0x000f000f
    s_mov_b32 exec_hi, 0x000f000f
    global_store_short v5, v16, s[56:57]
    s_cmp_lg_u32 s26, 0
    s_cbranch_scc1 L_tfe
    s_mov_b64 exec, 1
    v_mov_b32 v18, s6
    global_store_dword v10, v18, s[60:61]
L_tfe:
    s_endpgm
L_exit:
    s_endpgm
.p2align 6
.type L_tab,@object
L_tab:
.long 0x900f
.long 0x181100f
.long 0x208010
.long 0x1181100f
.long 0x40900f
.long 0x2181100f
.long 0x60900f
.long 0x3181100f
.long 0x49014
.long 0x3851014
.long 0x248016
.long 0x13851014
.long 0x449014
.long 0x23851014
.long 0x649014
.long 0x33851014
.long 0x89019
.long 0x5891019
.long 0x28801c
.long 0x15891019
.long 0x489019
.long 0x25891019
.long 0x689019
.long 0x35891019
.long 0xc901e
.long 0x78d401b
.long 0x2c8022
.long 0x178d401b
.long 0x4c901e
.long 0x278d401b
.long 0x6c901e
.long 0x378d401b
.long 0x109023
.long 0x9911020
.long 0x309027
.long 0x19911020
.long 0x509023
.long 0x29911020
.long 0x709023
.long 0x39911020
.long 0x149028
.long 0xb951025
.long 0x34902c
.long 0x1b951025
.long 0x549028
.long 0x2b951025
.long 0x749028
.long 0x3b951025
.long 0x18902d
.long 0xd99102a
.long 0x389031
.long 0x1d99102a
.long 0x58902d
.long 0x2d99102a
.long 0x78902d
.long 0x3d99102a
.long 0x1c9032
.long 0xf9d102f
.long 0x3c9036
.long 0x1f9d102f
.long 0x5c9032
.long 0x2f9d102f
.long 0x7c9032
.long 0x3f9d102f
.long 0x12036
.long 0x821034
.long 0x1203a
.long 0x821034
.long 0x12036
.long 0x821034
.long 0x12036
.long 0x821034
.long 0x5203a
.long 0x2861039
.long 0x5103f
.long 0x2861039
.long 0x5203a
.long 0x2861039
.long 0x5203a
.long 0x2861039
.long 0x9203e
.long 0x48a103e
.long 0x91044
.long 0x48a103e
.long 0x9203e
.long 0x48a103e
.long 0x9203e
.long 0x48a103e
.long 0xd503f
.long 0x68e503f
.long 0xd5045
.long 0x68e503f
.long 0xd503f
.long 0x68e503f
.long 0xd503f
.long 0x68e503f
.long 0x112043
.long 0x8921044
.long 0x11104a
.long 0x8921044
.long 0x112043
.long 0x8921044
.long 0x112043
.long 0x8921044
.long 0x152047
.long 0xa961049
.long 0x15104f
.long 0xa961049
.long 0x152047
.long 0xa961049
.long 0x152047
.long 0xa961049
.long 0x19204b
.long 0xc9a204d
.long 0x191054
.long 0xc9a204d
.long 0x19204b
.long 0xc9a204d
.long 0x19204b
.long 0xc9a204d
.long 0x1d204f
.long 0xe9e2051
.long 0x1d1059
.long 0xe9e2051
.long 0x1d204f
.long 0xe9e2051
.long 0x1d204f
.long 0xe9e2051
.long 0x822053
.long 0x28057
.long 0x82205d
.long 0xa8057
.long 0x822053
.long 0x128057
.long 0x822053
.long 0x1a8057
.long 0x2862057
.long 0x6805d
.long 0x2862061
.long 0xe805d
.long 0x2862057
.long 0x16805d
.long 0x2862057
.long 0x1e805d
.long 0x48a205b
.long 0x1b002061
.long 0x48a2065
.long 0x37002061
.long 0x48a205b
.long 0x53002061
.long 0x48a205b
.long 0x6f003060
.long 0x68e505c
.long 0x19002065
.long 0x68e5066
.long 0x35002065
.long 0x68e505c
.long 0x51002065
.long 0x68e505c
.long 0x6d003063
.long 0x8922060
.long 0x17002069
.long 0x892206a
.long 0x33002069
.long 0x8922060
.long 0x4f003068
.long 0x8922060
.long 0x6b002067
.long 0xa962064
.long 0x1500306c
.long 0xa96206e
.long 0x3100306c
.long 0xa962064
.long 0x4d00306b
.long 0xa962064
.long 0x6900206b
.long 0xc9a2068
.long 0x1300306f
.long 0xc9a2072
.long 0x2f00306f
.long 0xc9a2068
.long 0x4b00206f
.long 0xc9a2068
.long 0x6700206f
.long 0xe9e206c
.long 0x11003072
.long 0xe9e2076
.long 0x2d003072
.long 0xe9e206c
.long 0x49003072
.long 0xe9e206c
.long 0x65003072
.long 0x1b06f
.long 0xf003075
.long 0x21a07a
.long 0x2b003075
.long 0x41b06f
.long 0x47003075
.long 0x61b06f
.long 0x63003075
.long 0x5b072
.long 0xd003078
.long 0x25a07e
.long 0x29003078
.long 0x45b072
.long 0x45003078
.long 0x65b072
.long 0x61003078
.long 0x9a076
.long 0xb00307b
.long 0x29a082
.long 0x2700307b
.long 0x49a076
.long 0x4300307b
.long 0x69a076
.long 0x5f00307b
.long 0xda07a
.long 0x900307e
.long 0x2da086
.long 0x2500307e
.long 0x4da07a
.long 0x4100307e
.long 0x6da07a
.long 0x5d00307e
.long 0x11a07e
.long 0x7003081
.long 0x31d087
.long 0x23003081
.long 0x51a07e
.long 0x3f003081
.long 0x71a07e
.long 0x5b003081
.long 0x15a082
.long 0x5003084
.long 0x35d088
.long 0x21003084
.long 0x55a082
.long 0x3d003084
.long 0x75a082
.long 0x59003084
.long 0x19a086
.long 0x3003087
.long 0x39d089
.long 0x1f003087
.long 0x59a086
.long 0x3b003087
.long 0x79a086
.long 0x57003087
.long 0x1da08a
.long 0x100308a
.long 0x3dd08a
.long 0x1d00308a
.long 0x5da08a
.long 0x3900308a
.long 0x7da08a
.long 0x5500308a
L_endcode:
.section .rodata,"a"
.p2align 6
.amdhsa_kernel adaLN_cond__gqa_block_cached__dense_activation_relu__decode_kernel
.amdhsa_next_free_vgpr 168
.amdhsa_next_free_sgpr 102
.amdhsa_accum_offset 168
.amdhsa_group_segment_fixed_size 0
.amdhsa_kernarg_size 104
.amdhsa_user_sgpr_count 2
.amdhsa_user_sgpr_kernarg_segment_ptr 1
.amdhsa_system_sgpr_workgroup_id_x 1
.end_amdhsa_kernel
```
